```python
import torch

def _softmax(x, axis=-1):
    return torch.softmax(x, dim=axis)
def _gelu(x):
    return torch.nn.functional.gelu(x, approximate="tanh")
def _silu(x):
    return torch.nn.functional.silu(x)
def _sigmoid(x):
    return torch.sigmoid(x)
def _layernorm(x, axis=-1, eps=1e-5):
    m = x.mean(dim=axis, keepdim=True)
    v = x.var(dim=axis, keepdim=True, unbiased=False)
    return (x - m) / torch.sqrt(v + eps)
def _scatter_add(tgt, idx, src, axis=0):
    return tgt.clone().index_add_(axis, idx, src)
def _segment_sum(src, seg, n):
    out = torch.zeros((n,) + src.shape[1:], dtype=src.dtype)
    return out.index_add_(0, seg, src)
def _pad(x, pw):
    flat = tuple(v for pair in reversed(pw) for v in pair)
    return torch.nn.functional.pad(x, flat)

kernel_name = 'gated_mix__mha_block__geglu_ffn__prompt'

def setup_inputs():

    _w = (lambda a: (lambda t: t.to(torch.bfloat16) if t.is_floating_point() else t)(torch.as_tensor(a)))
    def _A_setup():
        B, S, D, H = 1, 2048, 1024, 32
        return {
            "x": _w((lambda *s: torch.randn(*s, dtype=torch.bfloat16) * 0.05)(B, S, D)),
            "wqkv": _w((lambda *s: torch.randn(*s, dtype=torch.bfloat16) * 0.8)(D, 3 * D)),
            "wo": _w((lambda *s: torch.randn(*s, dtype=torch.bfloat16) * 0.05)(D, D)),
        }
    _A_in = _A_setup()

    def _B_setup():
        B, S, D, F = 1, 2048, 1024, 3584
        return {
            "x": _w((lambda *s: torch.randn(*s, dtype=torch.bfloat16) * 0.05)(B, S, D)),
            "w_gate": _w((lambda *s: torch.randn(*s, dtype=torch.bfloat16) * 0.1)(D, F)),
            "w_up": _w((lambda *s: torch.randn(*s, dtype=torch.bfloat16) * 0.1)(D, F)),
            "w_down": _w((lambda *s: torch.randn(*s, dtype=torch.bfloat16) * 0.1)(F, D)),
        }
    _B_in = _B_setup()

    return {
        "A_x": _A_in["x"],
        "A_wqkv": _A_in["wqkv"],
        "A_wo": _A_in["wo"],
        "B_x": _B_in["x"],
        "B_w_gate": _B_in["w_gate"],
        "B_w_up": _B_in["w_up"],
        "B_w_down": _B_in["w_down"],
        "gate_w": _w((lambda *s: torch.randn(*s, dtype=torch.bfloat16) * 0.05)(1024) * 16.0),
    }

def reference(A_x, A_wqkv, A_wo, B_x, B_w_gate, B_w_up, B_w_down, gate_w):
    def _A_ref(x, wqkv, wo):
        B, S, D = x.shape
        H = 32
        Dh = D // H
        qkv = (lambda x, *d: x.permute(*d))((x @ wqkv).reshape(B, S, 3, H, Dh), 2, 0, 3, 1, 4)
        q, k, v = qkv[0], qkv[1], qkv[2]
        scores = torch.einsum("bhqd,bhkd->bhqk", q, k) * (Dh ** -0.5)
        p = _softmax(scores, axis=-1)
        o = torch.einsum("bhqk,bhkd->bhqd", p, v)
        return (lambda x, *d: x.permute(*d))(o, 0, 2, 1, 3).reshape(B, S, D) @ wo

    def _B_ref(x, w_gate, w_up, w_down):
        return (_gelu(x @ w_gate) * (x @ w_up)) @ w_down

    x = A_x
    g = _sigmoid((x * gate_w).sum(-1, keepdims=True))
    a = _A_ref(x, A_wqkv, A_wo)
    b = _B_ref(x, B_w_gate, B_w_up, B_w_down)
    return g * a + (1 - g) * b
```

```asm
; @launch kernel=k1_kernel grid=(256,1,1) block=(512,1,1) lds=157760
; @launch kernel=k2_kernel grid=(512,1,1) block=(512,1,1) lds=73728
.amdgcn_target "amdgcn-amd-amdhsa--gfx950"
.text
.globl k1_kernel
.p2align 8
.type k1_kernel,@function
k1_kernel:
    s_cmp_ge_u32 s2, 256
    s_cbranch_scc1 L_k1_end
    s_load_dwordx4 s[24:27], s[0:1], 0
    s_load_dwordx4 s[48:51], s[0:1], 32
    s_load_dwordx2 s[32:33], s[0:1], 56
    s_load_dwordx2 s[30:31], s[0:1], 80
    v_lshrrev_b32 v1, 6, v0
    v_and_b32 v0, 63, v0
    v_readfirstlane_b32 s34, v1
    s_waitcnt lgkmcnt(0)
    s_mov_b32 s20, s30
    s_mov_b32 s21, s31
    s_mov_b32 s22, 0x10000000
    s_mov_b32 s23, 0x00020000
    s_mov_b32 s8, s24
    s_mov_b32 s9, s25
    s_mov_b32 s10, 0x400000
    s_mov_b32 s11, 0x00020000
    s_mov_b32 s12, s48
    s_mov_b32 s13, s49
    s_mov_b32 s14, 0x700000
    s_mov_b32 s15, 0x00020000
    s_mov_b32 s16, s50
    s_mov_b32 s17, s51
    s_mov_b32 s18, 0x700000
    s_mov_b32 s19, 0x00020000
    s_mov_b32 s60, s26
    s_mov_b32 s61, s27
    s_mov_b32 s62, 0x600000
    s_mov_b32 s63, 0x00020000
    s_mov_b32 s64, s32
    s_mov_b32 s65, s33
    s_mov_b32 s66, 0x800
    s_mov_b32 s67, 0x00020000
    s_or_b32 s45, s2, s34
    s_cmp_lg_u32 s45, 0
    s_cbranch_scc1 L_k1_nz
    v_lshlrev_b32 v7, 8, v0
    v_mov_b32 v8, 0
    s_mov_b32 s45, 33619968
    s_mov_b64 exec, 0xff
    buffer_store_dword v8, v7, s[20:23], s45 offen
    s_mov_b64 exec, -1
L_k1_nz:
    s_and_b32 s45, s2, 7
    s_lshr_b32 s46, s2, 3
    s_and_b32 s47, s46, 3
    s_lshl_b32 s38, s45, 2
    s_add_u32 s38, s38, s47
    s_lshr_b32 s37, s46, 2
    s_lshr_b32 s35, s34, 1
    s_and_b32 s36, s34, 1
    s_lshl_b32 s45, s37, 8
    s_lshl_b32 s46, s38, 3
    s_add_u32 s45, s45, s46
    s_add_u32 s54, s45, s34
    s_lshl_b32 s55, s54, 11
    v_lshrrev_b32 v7, 2, v0
    v_lshlrev_b32 v1, 11, v7
    v_lshrrev_b32 v8, 5, v0
    v_mul_u32_u24 v8, 3, v8
    v_and_b32 v9, 3, v0
    v_xor_b32 v8, v8, v9
    v_lshl_add_u32 v1, v8, 4, v1
    s_lshl_b32 s45, s37, 8
    s_lshl_b32 s46, s34, 5
    s_add_u32 s45, s45, s46
    s_lshl_b32 s45, s45, 11
    v_add_u32 v1, s45, v1
    v_mul_u32_u24 v7, 4682, v0
    v_lshrrev_b32 v7, 16, v7
    v_mul_u32_u24 v8, 14, v7
    v_sub_u32 v8, v0, v8
    s_movk_i32 s45, 7168
    v_mul_lo_u32 v2, v7, s45
    v_lshl_add_u32 v2, v8, 4, v2
    s_mul_i32 s46, s38, 224
    s_mul_i32 s47, s34, 28672
    s_add_u32 s46, s46, s47
    v_add_u32 v2, s46, v2
    v_min_u32 v8, 11, v8
    s_movk_i32 s45, 6144
    v_mul_lo_u32 v10, v7, s45
    v_lshrrev_b32 v9, 2, v8
    v_lshl_add_u32 v10, v9, 11, v10
    v_and_b32 v9, 3, v8
    v_lshl_add_u32 v10, v9, 4, v10
    s_lshl_b32 s46, s38, 6
    s_mul_i32 s47, s34, 24576
    s_add_u32 s46, s46, s47
    v_add_u32 v10, s46, v10
    s_lshl_b32 s41, s34, 11
    s_mul_i32 s42, s34, 896
    s_lshr_b32 s45, s34, 1
    s_lshl_b32 s45, s45, 7
    s_add_u32 s42, s42, s45
    s_add_u32 s42, s42, 16384
    s_mov_b32 s39, 0
    s_mov_b32 s40, 0
    s_mov_b32 s56, 0
    v_and_b32 v7, 15, v0
    v_lshrrev_b32 v8, 4, v0
    v_bfe_u32 v9, v0, 3, 1
    v_mul_u32_u24 v9, 3, v9
    v_xor_b32 v9, v9, v8
    v_lshlrev_b32 v3, 6, v7
    v_lshl_add_u32 v3, v9, 4, v3
    s_lshl_b32 s45, s35, 12
    v_add_u32 v3, s45, v3
    v_lshrrev_b32 v9, 2, v7
    v_lshl_add_u32 v9, v8, 3, v9
    v_mul_u32_u24 v5, 224, v9
    v_lshl_add_u32 v5, v8, 7, v5
    v_and_b32 v9, 3, v0
    v_lshl_add_u32 v6, v9, 3, v5
    s_lshl_b32 s45, s36, 5
    s_add_u32 s45, s45, 31760
    v_add_u32 v6, s45, v6
    v_bfe_u32 v9, v0, 1, 1
    v_mul_u32_u24 v9, 7696, v9
    v_add_u32 v5, v5, v9
    v_and_b32 v9, 1, v0
    v_lshl_add_u32 v5, v9, 3, v5
    s_mul_i32 s45, s36, 112
    s_add_u32 s45, s45, 16384
    v_add_u32 v5, s45, v5
    s_lshl_b32 s57, s37, 2
    s_and_b32 s45, s38, 3
    s_add_u32 s57, s57, s45
    s_lshl_b32 s39, s57, 6
    s_mul_i32 s40, s57, 229376
    s_mul_i32 s56, s57, 196608
    s_add_u32 m0, s41, 0
    s_nop 0
    buffer_load_dwordx4 v1, s[8:11], s39 offen lds
    s_add_u32 m0, s41, 1024
    s_add_u32 s43, s39, 32768
    buffer_load_dwordx4 v1, s[8:11], s43 offen lds
    s_add_u32 m0, s42, 0
    s_nop 0
    buffer_load_dwordx4 v2, s[12:15], s40 offen lds
    s_add_u32 m0, s42, 7696
    s_nop 0
    buffer_load_dwordx4 v2, s[16:19], s40 offen lds
    s_add_u32 m0, s42, 15376
    s_nop 0
    buffer_load_dwordx4 v10, s[60:63], s56 offen lds
    s_add_u32 s57, s57, 1
    s_and_b32 s57, s57, 31
    s_lshl_b32 s39, s57, 6
    s_mul_i32 s40, s57, 229376
    s_mul_i32 s56, s57, 196608
    s_add_u32 m0, s41, 39440
    s_nop 0
    buffer_load_dwordx4 v1, s[8:11], s39 offen lds
    s_add_u32 m0, s41, 40464
    s_add_u32 s43, s39, 32768
    buffer_load_dwordx4 v1, s[8:11], s43 offen lds
    s_add_u32 m0, s42, 39440
    s_nop 0
    buffer_load_dwordx4 v2, s[12:15], s40 offen lds
    s_add_u32 m0, s42, 47136
    s_nop 0
    buffer_load_dwordx4 v2, s[16:19], s40 offen lds
    s_add_u32 m0, s42, 54816
    s_nop 0
    buffer_load_dwordx4 v10, s[60:63], s56 offen lds
    s_add_u32 s57, s57, 1
    s_and_b32 s57, s57, 31
    s_lshl_b32 s39, s57, 6
    s_mul_i32 s40, s57, 229376
    s_mul_i32 s56, s57, 196608
    v_mov_b32 v12, 0
    v_mov_b32 v13, 0
    v_mov_b32 v14, 0
    v_mov_b32 v15, 0
    v_mov_b32 v16, 0
    v_mov_b32 v17, 0
    v_mov_b32 v18, 0
    v_mov_b32 v19, 0
    v_mov_b32 v20, 0
    v_mov_b32 v21, 0
    v_mov_b32 v22, 0
    v_mov_b32 v23, 0
    v_mov_b32 v24, 0
    v_mov_b32 v25, 0
    v_mov_b32 v26, 0
    v_mov_b32 v27, 0
    v_mov_b32 v28, 0
    v_mov_b32 v29, 0
    v_mov_b32 v30, 0
    v_mov_b32 v31, 0
    v_mov_b32 v32, 0
    v_mov_b32 v33, 0
    v_mov_b32 v34, 0
    v_mov_b32 v35, 0
    v_mov_b32 v36, 0
    v_mov_b32 v37, 0
    v_mov_b32 v38, 0
    v_mov_b32 v39, 0
    v_mov_b32 v40, 0
    v_mov_b32 v41, 0
    v_mov_b32 v42, 0
    v_mov_b32 v43, 0
    v_mov_b32 v44, 0
    v_mov_b32 v45, 0
    v_mov_b32 v46, 0
    v_mov_b32 v47, 0
    v_mov_b32 v48, 0
    v_mov_b32 v49, 0
    v_mov_b32 v50, 0
    v_mov_b32 v51, 0
    v_mov_b32 v52, 0
    v_mov_b32 v53, 0
    v_mov_b32 v54, 0
    v_mov_b32 v55, 0
    v_mov_b32 v56, 0
    v_mov_b32 v57, 0
    v_mov_b32 v58, 0
    v_mov_b32 v59, 0
    v_mov_b32 v60, 0
    v_mov_b32 v61, 0
    v_mov_b32 v62, 0
    v_mov_b32 v63, 0
    v_mov_b32 v64, 0
    v_mov_b32 v65, 0
    v_mov_b32 v66, 0
    v_mov_b32 v67, 0
    v_mov_b32 v68, 0
    v_mov_b32 v69, 0
    v_mov_b32 v70, 0
    v_mov_b32 v71, 0
    v_mov_b32 v72, 0
    v_mov_b32 v73, 0
    v_mov_b32 v74, 0
    v_mov_b32 v75, 0
    v_mov_b32 v76, 0
    v_mov_b32 v77, 0
    v_mov_b32 v78, 0
    v_mov_b32 v79, 0
    v_mov_b32 v80, 0
    v_mov_b32 v81, 0
    v_mov_b32 v82, 0
    v_mov_b32 v83, 0
    v_mov_b32 v84, 0
    v_mov_b32 v85, 0
    v_mov_b32 v86, 0
    v_mov_b32 v87, 0
    v_mov_b32 v88, 0
    v_mov_b32 v89, 0
    v_mov_b32 v90, 0
    v_mov_b32 v91, 0
    v_mov_b32 v92, 0
    v_mov_b32 v93, 0
    v_mov_b32 v94, 0
    v_mov_b32 v95, 0
    v_mov_b32 v96, 0
    v_mov_b32 v97, 0
    v_mov_b32 v98, 0
    v_mov_b32 v99, 0
    v_mov_b32 v100, 0
    v_mov_b32 v101, 0
    v_mov_b32 v102, 0
    v_mov_b32 v103, 0
    v_mov_b32 v104, 0
    v_mov_b32 v105, 0
    v_mov_b32 v106, 0
    v_mov_b32 v107, 0
    v_mov_b32 v108, 0
    v_mov_b32 v109, 0
    v_mov_b32 v110, 0
    v_mov_b32 v111, 0
    v_mov_b32 v112, 0
    v_mov_b32 v113, 0
    v_mov_b32 v114, 0
    v_mov_b32 v115, 0
    v_mov_b32 v116, 0
    v_mov_b32 v117, 0
    v_mov_b32 v118, 0
    v_mov_b32 v119, 0
    v_mov_b32 v120, 0
    v_mov_b32 v121, 0
    v_mov_b32 v122, 0
    v_mov_b32 v123, 0
    v_mov_b32 v124, 0
    v_mov_b32 v125, 0
    v_mov_b32 v126, 0
    v_mov_b32 v127, 0
    v_mov_b32 v128, 0
    v_mov_b32 v129, 0
    v_mov_b32 v130, 0
    v_mov_b32 v131, 0
    v_mov_b32 v132, 0
    v_mov_b32 v133, 0
    v_mov_b32 v134, 0
    v_mov_b32 v135, 0
    v_mov_b32 v136, 0
    v_mov_b32 v137, 0
    v_mov_b32 v138, 0
    v_mov_b32 v139, 0
    v_mov_b32 v140, 0
    v_mov_b32 v141, 0
    v_mov_b32 v142, 0
    v_mov_b32 v143, 0
    v_mov_b32 v144, 0
    v_mov_b32 v145, 0
    v_mov_b32 v146, 0
    v_mov_b32 v147, 0
    v_mov_b32 v148, 0
    v_mov_b32 v149, 0
    v_mov_b32 v150, 0
    v_mov_b32 v151, 0
    v_mov_b32 v152, 0
    v_mov_b32 v153, 0
    v_mov_b32 v154, 0
    v_mov_b32 v155, 0
    v_mov_b32 v156, 0
    v_mov_b32 v157, 0
    v_mov_b32 v158, 0
    v_mov_b32 v159, 0
    v_mov_b32 v160, 0
    v_mov_b32 v161, 0
    v_mov_b32 v162, 0
    v_mov_b32 v163, 0
    v_mov_b32 v164, 0
    v_mov_b32 v165, 0
    v_mov_b32 v166, 0
    v_mov_b32 v167, 0
    v_mov_b32 v168, 0
    v_mov_b32 v169, 0
    v_mov_b32 v170, 0
    v_mov_b32 v171, 0
    s_waitcnt vmcnt(5)
    s_barrier
    ds_read_b128 v[172:175], v3 offset:0
    ds_read_b128 v[176:179], v3 offset:1024
    ds_read_b128 v[180:183], v3 offset:2048
    ds_read_b128 v[184:187], v3 offset:3072
    ds_read_b64_tr_b16 v[204:205], v5 offset:0
    ds_read_b64_tr_b16 v[206:207], v5 offset:896
    ds_read_b64_tr_b16 v[208:209], v5 offset:16
    ds_read_b64_tr_b16 v[210:211], v5 offset:912
    ds_read_b64_tr_b16 v[212:213], v5 offset:32
    ds_read_b64_tr_b16 v[214:215], v5 offset:928
    ds_read_b64_tr_b16 v[216:217], v5 offset:48
    ds_read_b64_tr_b16 v[218:219], v5 offset:944
    ds_read_b64_tr_b16 v[220:221], v5 offset:64
    ds_read_b64_tr_b16 v[222:223], v5 offset:960
    ds_read_b64_tr_b16 v[224:225], v5 offset:80
    ds_read_b64_tr_b16 v[226:227], v5 offset:976
    ds_read_b64_tr_b16 v[228:229], v5 offset:96
    ds_read_b64_tr_b16 v[230:231], v5 offset:992
    ds_read_b64_tr_b16 v[232:233], v6 offset:0
    ds_read_b64_tr_b16 v[234:235], v6 offset:896
    ds_read_b64_tr_b16 v[236:237], v6 offset:64
    ds_read_b64_tr_b16 v[238:239], v6 offset:960
    ds_read_b64_tr_b16 v[240:241], v6 offset:128
    ds_read_b64_tr_b16 v[242:243], v6 offset:1024
    s_waitcnt lgkmcnt(0)
    s_waitcnt vmcnt(0)
    s_barrier
    v_add_u32 v3, 39440, v3
    v_add_u32 v5, 39440, v5
    v_add_u32 v6, 39440, v6
    v_mfma_f32_16x16x32_bf16 v[12:15], v[204:207], v[172:175], v[12:15]
    ds_read_b128 v[188:191], v3 offset:0
    v_mfma_f32_16x16x32_bf16 v[52:55], v[204:207], v[176:179], v[52:55]
    ds_read_b128 v[192:195], v3 offset:1024
    v_mfma_f32_16x16x32_bf16 v[92:95], v[204:207], v[180:183], v[92:95]
    s_add_u32 m0, s41, 78880
    s_nop 0
    buffer_load_dwordx4 v1, s[8:11], s39 offen lds
    s_add_u32 m0, s41, 79904
    s_add_u32 s43, s39, 32768
    buffer_load_dwordx4 v1, s[8:11], s43 offen lds
    v_mfma_f32_16x16x32_bf16 v[132:135], v[204:207], v[184:187], v[132:135]
    ds_read_b64_tr_b16 v[204:205], v5 offset:0
    ds_read_b64_tr_b16 v[206:207], v5 offset:896
    v_mfma_f32_16x16x32_bf16 v[16:19], v[208:211], v[172:175], v[16:19]
    ds_read_b128 v[196:199], v3 offset:2048
    v_mfma_f32_16x16x32_bf16 v[56:59], v[208:211], v[176:179], v[56:59]
    ds_read_b128 v[200:203], v3 offset:3072
    v_mfma_f32_16x16x32_bf16 v[96:99], v[208:211], v[180:183], v[96:99]
    s_add_u32 m0, s42, 78880
    s_nop 0
    buffer_load_dwordx4 v2, s[12:15], s40 offen lds
    s_add_u32 m0, s42, 86576
    s_nop 0
    buffer_load_dwordx4 v2, s[16:19], s40 offen lds
    v_mfma_f32_16x16x32_bf16 v[136:139], v[208:211], v[184:187], v[136:139]
    ds_read_b64_tr_b16 v[208:209], v5 offset:16
    ds_read_b64_tr_b16 v[210:211], v5 offset:912
    v_mfma_f32_16x16x32_bf16 v[20:23], v[212:215], v[172:175], v[20:23]
    ds_read_b64_tr_b16 v[244:245], v6 offset:64
    ds_read_b64_tr_b16 v[246:247], v6 offset:960
    v_mfma_f32_16x16x32_bf16 v[60:63], v[212:215], v[176:179], v[60:63]
    ds_read_b64_tr_b16 v[248:249], v6 offset:128
    ds_read_b64_tr_b16 v[250:251], v6 offset:1024
    v_mfma_f32_16x16x32_bf16 v[100:103], v[212:215], v[180:183], v[100:103]
    s_add_u32 m0, s42, 94256
    s_nop 0
    buffer_load_dwordx4 v10, s[60:63], s56 offen lds
    s_add_u32 s57, s57, 1
    s_and_b32 s57, s57, 31
    s_lshl_b32 s39, s57, 6
    s_mul_i32 s40, s57, 229376
    s_mul_i32 s56, s57, 196608
    v_mfma_f32_16x16x32_bf16 v[140:143], v[212:215], v[184:187], v[140:143]
    ds_read_b64_tr_b16 v[212:213], v5 offset:32
    ds_read_b64_tr_b16 v[214:215], v5 offset:928
    v_mfma_f32_16x16x32_bf16 v[24:27], v[216:219], v[172:175], v[24:27]
    v_mfma_f32_16x16x32_bf16 v[64:67], v[216:219], v[176:179], v[64:67]
    v_mfma_f32_16x16x32_bf16 v[104:107], v[216:219], v[180:183], v[104:107]
    s_add_u32 m0, s41, 118320
    s_nop 0
    buffer_load_dwordx4 v1, s[8:11], s39 offen lds
    s_add_u32 m0, s41, 119344
    s_add_u32 s43, s39, 32768
    buffer_load_dwordx4 v1, s[8:11], s43 offen lds
    v_mfma_f32_16x16x32_bf16 v[144:147], v[216:219], v[184:187], v[144:147]
    ds_read_b64_tr_b16 v[216:217], v5 offset:48
    ds_read_b64_tr_b16 v[218:219], v5 offset:944
    v_mfma_f32_16x16x32_bf16 v[28:31], v[220:223], v[172:175], v[28:31]
    v_mfma_f32_16x16x32_bf16 v[68:71], v[220:223], v[176:179], v[68:71]
    v_mfma_f32_16x16x32_bf16 v[108:111], v[220:223], v[180:183], v[108:111]
    s_add_u32 m0, s42, 118320
    s_nop 0
    buffer_load_dwordx4 v2, s[12:15], s40 offen lds
    s_add_u32 m0, s42, 126016
    s_nop 0
    buffer_load_dwordx4 v2, s[16:19], s40 offen lds
    v_mfma_f32_16x16x32_bf16 v[148:151], v[220:223], v[184:187], v[148:151]
    ds_read_b64_tr_b16 v[220:221], v5 offset:64
    ds_read_b64_tr_b16 v[222:223], v5 offset:960
    v_mfma_f32_16x16x32_bf16 v[32:35], v[224:227], v[172:175], v[32:35]
    v_mfma_f32_16x16x32_bf16 v[72:75], v[224:227], v[176:179], v[72:75]
    v_mfma_f32_16x16x32_bf16 v[112:115], v[224:227], v[180:183], v[112:115]
    s_add_u32 m0, s42, 133696
    s_nop 0
    buffer_load_dwordx4 v10, s[60:63], s56 offen lds
    s_add_u32 s57, s57, 1
    s_and_b32 s57, s57, 31
    s_lshl_b32 s39, s57, 6
    s_mul_i32 s40, s57, 229376
    s_mul_i32 s56, s57, 196608
    v_mfma_f32_16x16x32_bf16 v[152:155], v[224:227], v[184:187], v[152:155]
    ds_read_b64_tr_b16 v[224:225], v5 offset:80
    ds_read_b64_tr_b16 v[226:227], v5 offset:976
    v_mfma_f32_16x16x32_bf16 v[36:39], v[228:231], v[172:175], v[36:39]
    v_mfma_f32_16x16x32_bf16 v[76:79], v[228:231], v[176:179], v[76:79]
    v_mfma_f32_16x16x32_bf16 v[116:119], v[228:231], v[180:183], v[116:119]
    v_mfma_f32_16x16x32_bf16 v[156:159], v[228:231], v[184:187], v[156:159]
    ds_read_b64_tr_b16 v[228:229], v5 offset:96
    ds_read_b64_tr_b16 v[230:231], v5 offset:992
    v_mfma_f32_16x16x32_bf16 v[40:43], v[232:235], v[172:175], v[40:43]
    v_mfma_f32_16x16x32_bf16 v[80:83], v[232:235], v[176:179], v[80:83]
    v_mfma_f32_16x16x32_bf16 v[120:123], v[232:235], v[180:183], v[120:123]
    v_mfma_f32_16x16x32_bf16 v[160:163], v[232:235], v[184:187], v[160:163]
    ds_read_b64_tr_b16 v[232:233], v6 offset:0
    ds_read_b64_tr_b16 v[234:235], v6 offset:896
    v_mfma_f32_16x16x32_bf16 v[44:47], v[236:239], v[172:175], v[44:47]
    v_mfma_f32_16x16x32_bf16 v[84:87], v[236:239], v[176:179], v[84:87]
    v_mfma_f32_16x16x32_bf16 v[124:127], v[236:239], v[180:183], v[124:127]
    v_mfma_f32_16x16x32_bf16 v[164:167], v[236:239], v[184:187], v[164:167]
    v_mfma_f32_16x16x32_bf16 v[48:51], v[172:175], v[240:243], v[48:51]
    v_mfma_f32_16x16x32_bf16 v[88:91], v[176:179], v[240:243], v[88:91]
    v_mfma_f32_16x16x32_bf16 v[128:131], v[180:183], v[240:243], v[128:131]
    v_mfma_f32_16x16x32_bf16 v[168:171], v[184:187], v[240:243], v[168:171]
    s_waitcnt lgkmcnt(0)
    s_waitcnt vmcnt(5)
    s_barrier
    v_add_u32 v3, 39440, v3
    v_add_u32 v5, 39440, v5
    v_add_u32 v6, 39440, v6
    v_mfma_f32_16x16x32_bf16 v[12:15], v[204:207], v[188:191], v[12:15]
    ds_read_b128 v[172:175], v3 offset:0
    v_mfma_f32_16x16x32_bf16 v[52:55], v[204:207], v[192:195], v[52:55]
    ds_read_b128 v[176:179], v3 offset:1024
    v_mfma_f32_16x16x32_bf16 v[92:95], v[204:207], v[196:199], v[92:95]
    s_add_u32 m0, s41, 0
    s_nop 0
    buffer_load_dwordx4 v1, s[8:11], s39 offen lds
    s_add_u32 m0, s41, 1024
    s_add_u32 s43, s39, 32768
    buffer_load_dwordx4 v1, s[8:11], s43 offen lds
    v_mfma_f32_16x16x32_bf16 v[132:135], v[204:207], v[200:203], v[132:135]
    ds_read_b64_tr_b16 v[204:205], v5 offset:0
    ds_read_b64_tr_b16 v[206:207], v5 offset:896
    v_mfma_f32_16x16x32_bf16 v[16:19], v[208:211], v[188:191], v[16:19]
    ds_read_b128 v[180:183], v3 offset:2048
    v_mfma_f32_16x16x32_bf16 v[56:59], v[208:211], v[192:195], v[56:59]
    ds_read_b128 v[184:187], v3 offset:3072
    v_mfma_f32_16x16x32_bf16 v[96:99], v[208:211], v[196:199], v[96:99]
    s_add_u32 m0, s42, 0
    s_nop 0
    buffer_load_dwordx4 v2, s[12:15], s40 offen lds
    s_add_u32 m0, s42, 7696
    s_nop 0
    buffer_load_dwordx4 v2, s[16:19], s40 offen lds
    v_mfma_f32_16x16x32_bf16 v[136:139], v[208:211], v[200:203], v[136:139]
    ds_read_b64_tr_b16 v[208:209], v5 offset:16
    ds_read_b64_tr_b16 v[210:211], v5 offset:912
    v_mfma_f32_16x16x32_bf16 v[20:23], v[212:215], v[188:191], v[20:23]
    ds_read_b64_tr_b16 v[236:237], v6 offset:64
    ds_read_b64_tr_b16 v[238:239], v6 offset:960
    v_mfma_f32_16x16x32_bf16 v[60:63], v[212:215], v[192:195], v[60:63]
    ds_read_b64_tr_b16 v[240:241], v6 offset:128
    ds_read_b64_tr_b16 v[242:243], v6 offset:1024
    v_mfma_f32_16x16x32_bf16 v[100:103], v[212:215], v[196:199], v[100:103]
    s_add_u32 m0, s42, 15376
    s_nop 0
    buffer_load_dwordx4 v10, s[60:63], s56 offen lds
    s_add_u32 s57, s57, 1
    s_and_b32 s57, s57, 31
    s_lshl_b32 s39, s57, 6
    s_mul_i32 s40, s57, 229376
    s_mul_i32 s56, s57, 196608
    v_mfma_f32_16x16x32_bf16 v[140:143], v[212:215], v[200:203], v[140:143]
    ds_read_b64_tr_b16 v[212:213], v5 offset:32
    ds_read_b64_tr_b16 v[214:215], v5 offset:928
    v_mfma_f32_16x16x32_bf16 v[24:27], v[216:219], v[188:191], v[24:27]
    v_mfma_f32_16x16x32_bf16 v[64:67], v[216:219], v[192:195], v[64:67]
    v_mfma_f32_16x16x32_bf16 v[104:107], v[216:219], v[196:199], v[104:107]
    s_add_u32 m0, s41, 39440
    s_nop 0
    buffer_load_dwordx4 v1, s[8:11], s39 offen lds
    s_add_u32 m0, s41, 40464
    s_add_u32 s43, s39, 32768
    buffer_load_dwordx4 v1, s[8:11], s43 offen lds
    v_mfma_f32_16x16x32_bf16 v[144:147], v[216:219], v[200:203], v[144:147]
    ds_read_b64_tr_b16 v[216:217], v5 offset:48
    ds_read_b64_tr_b16 v[218:219], v5 offset:944
    v_mfma_f32_16x16x32_bf16 v[28:31], v[220:223], v[188:191], v[28:31]
    v_mfma_f32_16x16x32_bf16 v[68:71], v[220:223], v[192:195], v[68:71]
    v_mfma_f32_16x16x32_bf16 v[108:111], v[220:223], v[196:199], v[108:111]
    s_add_u32 m0, s42, 39440
    s_nop 0
    buffer_load_dwordx4 v2, s[12:15], s40 offen lds
    s_add_u32 m0, s42, 47136
    s_nop 0
    buffer_load_dwordx4 v2, s[16:19], s40 offen lds
    v_mfma_f32_16x16x32_bf16 v[148:151], v[220:223], v[200:203], v[148:151]
    ds_read_b64_tr_b16 v[220:221], v5 offset:64
    ds_read_b64_tr_b16 v[222:223], v5 offset:960
    v_mfma_f32_16x16x32_bf16 v[32:35], v[224:227], v[188:191], v[32:35]
    v_mfma_f32_16x16x32_bf16 v[72:75], v[224:227], v[192:195], v[72:75]
    v_mfma_f32_16x16x32_bf16 v[112:115], v[224:227], v[196:199], v[112:115]
    s_add_u32 m0, s42, 54816
    s_nop 0
    buffer_load_dwordx4 v10, s[60:63], s56 offen lds
    s_add_u32 s57, s57, 1
    s_and_b32 s57, s57, 31
    s_lshl_b32 s39, s57, 6
    s_mul_i32 s40, s57, 229376
    s_mul_i32 s56, s57, 196608
    v_mfma_f32_16x16x32_bf16 v[152:155], v[224:227], v[200:203], v[152:155]
    ds_read_b64_tr_b16 v[224:225], v5 offset:80
    ds_read_b64_tr_b16 v[226:227], v5 offset:976
    v_mfma_f32_16x16x32_bf16 v[36:39], v[228:231], v[188:191], v[36:39]
    v_mfma_f32_16x16x32_bf16 v[76:79], v[228:231], v[192:195], v[76:79]
    v_mfma_f32_16x16x32_bf16 v[116:119], v[228:231], v[196:199], v[116:119]
    v_mfma_f32_16x16x32_bf16 v[156:159], v[228:231], v[200:203], v[156:159]
    ds_read_b64_tr_b16 v[228:229], v5 offset:96
    ds_read_b64_tr_b16 v[230:231], v5 offset:992
    v_mfma_f32_16x16x32_bf16 v[40:43], v[232:235], v[188:191], v[40:43]
    v_mfma_f32_16x16x32_bf16 v[80:83], v[232:235], v[192:195], v[80:83]
    v_mfma_f32_16x16x32_bf16 v[120:123], v[232:235], v[196:199], v[120:123]
    v_mfma_f32_16x16x32_bf16 v[160:163], v[232:235], v[200:203], v[160:163]
    ds_read_b64_tr_b16 v[232:233], v6 offset:0
    ds_read_b64_tr_b16 v[234:235], v6 offset:896
    v_mfma_f32_16x16x32_bf16 v[44:47], v[244:247], v[188:191], v[44:47]
    v_mfma_f32_16x16x32_bf16 v[84:87], v[244:247], v[192:195], v[84:87]
    v_mfma_f32_16x16x32_bf16 v[124:127], v[244:247], v[196:199], v[124:127]
    v_mfma_f32_16x16x32_bf16 v[164:167], v[244:247], v[200:203], v[164:167]
    v_mfma_f32_16x16x32_bf16 v[48:51], v[188:191], v[248:251], v[48:51]
    v_mfma_f32_16x16x32_bf16 v[88:91], v[192:195], v[248:251], v[88:91]
    v_mfma_f32_16x16x32_bf16 v[128:131], v[196:199], v[248:251], v[128:131]
    v_mfma_f32_16x16x32_bf16 v[168:171], v[200:203], v[248:251], v[168:171]
    s_waitcnt lgkmcnt(0)
    s_waitcnt vmcnt(10)
    s_barrier
    v_add_u32 v3, 39440, v3
    v_add_u32 v5, 39440, v5
    v_add_u32 v6, 39440, v6
    v_mfma_f32_16x16x32_bf16 v[12:15], v[204:207], v[172:175], v[12:15]
    ds_read_b128 v[188:191], v3 offset:0
    v_mfma_f32_16x16x32_bf16 v[52:55], v[204:207], v[176:179], v[52:55]
    ds_read_b128 v[192:195], v3 offset:1024
    v_mfma_f32_16x16x32_bf16 v[92:95], v[204:207], v[180:183], v[92:95]
    s_add_u32 m0, s41, 78880
    s_nop 0
    buffer_load_dwordx4 v1, s[8:11], s39 offen lds
    v_mfma_f32_16x16x32_bf16 v[132:135], v[204:207], v[184:187], v[132:135]
    ds_read_b64_tr_b16 v[204:205], v5 offset:0
    ds_read_b64_tr_b16 v[206:207], v5 offset:896
    v_mfma_f32_16x16x32_bf16 v[16:19], v[208:211], v[172:175], v[16:19]
    ds_read_b128 v[196:199], v3 offset:2048
    v_mfma_f32_16x16x32_bf16 v[56:59], v[208:211], v[176:179], v[56:59]
    ds_read_b128 v[200:203], v3 offset:3072
    v_mfma_f32_16x16x32_bf16 v[96:99], v[208:211], v[180:183], v[96:99]
    s_add_u32 m0, s41, 79904
    s_add_u32 s43, s39, 32768
    buffer_load_dwordx4 v1, s[8:11], s43 offen lds
    v_mfma_f32_16x16x32_bf16 v[136:139], v[208:211], v[184:187], v[136:139]
    ds_read_b64_tr_b16 v[208:209], v5 offset:16
    ds_read_b64_tr_b16 v[210:211], v5 offset:912
    v_mfma_f32_16x16x32_bf16 v[20:23], v[212:215], v[172:175], v[20:23]
    ds_read_b64_tr_b16 v[244:245], v6 offset:64
    ds_read_b64_tr_b16 v[246:247], v6 offset:960
    v_mfma_f32_16x16x32_bf16 v[60:63], v[212:215], v[176:179], v[60:63]
    ds_read_b64_tr_b16 v[248:249], v6 offset:128
    ds_read_b64_tr_b16 v[250:251], v6 offset:1024
    v_mfma_f32_16x16x32_bf16 v[100:103], v[212:215], v[180:183], v[100:103]
    s_add_u32 m0, s42, 78880
    s_nop 0
    buffer_load_dwordx4 v2, s[12:15], s40 offen lds
    v_mfma_f32_16x16x32_bf16 v[140:143], v[212:215], v[184:187], v[140:143]
    ds_read_b64_tr_b16 v[212:213], v5 offset:32
    ds_read_b64_tr_b16 v[214:215], v5 offset:928
    v_mfma_f32_16x16x32_bf16 v[24:27], v[216:219], v[172:175], v[24:27]
    v_mfma_f32_16x16x32_bf16 v[64:67], v[216:219], v[176:179], v[64:67]
    v_mfma_f32_16x16x32_bf16 v[104:107], v[216:219], v[180:183], v[104:107]
    s_add_u32 m0, s42, 86576
    s_nop 0
    buffer_load_dwordx4 v2, s[16:19], s40 offen lds
    v_mfma_f32_16x16x32_bf16 v[144:147], v[216:219], v[184:187], v[144:147]
    ds_read_b64_tr_b16 v[216:217], v5 offset:48
    ds_read_b64_tr_b16 v[218:219], v5 offset:944
    v_mfma_f32_16x16x32_bf16 v[28:31], v[220:223], v[172:175], v[28:31]
    v_mfma_f32_16x16x32_bf16 v[68:71], v[220:223], v[176:179], v[68:71]
    v_mfma_f32_16x16x32_bf16 v[108:111], v[220:223], v[180:183], v[108:111]
    s_add_u32 m0, s42, 94256
    s_nop 0
    buffer_load_dwordx4 v10, s[60:63], s56 offen lds
    v_mfma_f32_16x16x32_bf16 v[148:151], v[220:223], v[184:187], v[148:151]
    ds_read_b64_tr_b16 v[220:221], v5 offset:64
    ds_read_b64_tr_b16 v[222:223], v5 offset:960
    v_mfma_f32_16x16x32_bf16 v[32:35], v[224:227], v[172:175], v[32:35]
    v_mfma_f32_16x16x32_bf16 v[72:75], v[224:227], v[176:179], v[72:75]
    v_mfma_f32_16x16x32_bf16 v[112:115], v[224:227], v[180:183], v[112:115]
    s_add_u32 s57, s57, 1
    s_and_b32 s57, s57, 31
    s_lshl_b32 s39, s57, 6
    s_mul_i32 s40, s57, 229376
    s_mul_i32 s56, s57, 196608
    v_mfma_f32_16x16x32_bf16 v[152:155], v[224:227], v[184:187], v[152:155]
    ds_read_b64_tr_b16 v[224:225], v5 offset:80
    ds_read_b64_tr_b16 v[226:227], v5 offset:976
    v_mfma_f32_16x16x32_bf16 v[36:39], v[228:231], v[172:175], v[36:39]
    v_mfma_f32_16x16x32_bf16 v[76:79], v[228:231], v[176:179], v[76:79]
    v_mfma_f32_16x16x32_bf16 v[116:119], v[228:231], v[180:183], v[116:119]
    v_mfma_f32_16x16x32_bf16 v[156:159], v[228:231], v[184:187], v[156:159]
    ds_read_b64_tr_b16 v[228:229], v5 offset:96
    ds_read_b64_tr_b16 v[230:231], v5 offset:992
    v_mfma_f32_16x16x32_bf16 v[40:43], v[232:235], v[172:175], v[40:43]
    v_mfma_f32_16x16x32_bf16 v[80:83], v[232:235], v[176:179], v[80:83]
    v_mfma_f32_16x16x32_bf16 v[120:123], v[232:235], v[180:183], v[120:123]
    v_mfma_f32_16x16x32_bf16 v[160:163], v[232:235], v[184:187], v[160:163]
    ds_read_b64_tr_b16 v[232:233], v6 offset:0
    ds_read_b64_tr_b16 v[234:235], v6 offset:896
    v_mfma_f32_16x16x32_bf16 v[44:47], v[236:239], v[172:175], v[44:47]
    v_mfma_f32_16x16x32_bf16 v[84:87], v[236:239], v[176:179], v[84:87]
    v_mfma_f32_16x16x32_bf16 v[124:127], v[236:239], v[180:183], v[124:127]
    v_mfma_f32_16x16x32_bf16 v[164:167], v[236:239], v[184:187], v[164:167]
    v_mfma_f32_16x16x32_bf16 v[48:51], v[172:175], v[240:243], v[48:51]
    v_mfma_f32_16x16x32_bf16 v[88:91], v[176:179], v[240:243], v[88:91]
    v_mfma_f32_16x16x32_bf16 v[128:131], v[180:183], v[240:243], v[128:131]
    v_mfma_f32_16x16x32_bf16 v[168:171], v[184:187], v[240:243], v[168:171]
    s_waitcnt lgkmcnt(0)
    s_waitcnt vmcnt(10)
    s_barrier
    v_subrev_u32 v3, 118320, v3
    v_subrev_u32 v5, 118320, v5
    v_subrev_u32 v6, 118320, v6
    v_mfma_f32_16x16x32_bf16 v[12:15], v[204:207], v[188:191], v[12:15]
    ds_read_b128 v[172:175], v3 offset:0
    v_mfma_f32_16x16x32_bf16 v[52:55], v[204:207], v[192:195], v[52:55]
    ds_read_b128 v[176:179], v3 offset:1024
    v_mfma_f32_16x16x32_bf16 v[92:95], v[204:207], v[196:199], v[92:95]
    s_add_u32 m0, s41, 118320
    s_nop 0
    buffer_load_dwordx4 v1, s[8:11], s39 offen lds
    v_mfma_f32_16x16x32_bf16 v[132:135], v[204:207], v[200:203], v[132:135]
    ds_read_b64_tr_b16 v[204:205], v5 offset:0
    ds_read_b64_tr_b16 v[206:207], v5 offset:896
    v_mfma_f32_16x16x32_bf16 v[16:19], v[208:211], v[188:191], v[16:19]
    ds_read_b128 v[180:183], v3 offset:2048
    v_mfma_f32_16x16x32_bf16 v[56:59], v[208:211], v[192:195], v[56:59]
    ds_read_b128 v[184:187], v3 offset:3072
    v_mfma_f32_16x16x32_bf16 v[96:99], v[208:211], v[196:199], v[96:99]
    s_add_u32 m0, s41, 119344
    s_add_u32 s43, s39, 32768
    buffer_load_dwordx4 v1, s[8:11], s43 offen lds
    v_mfma_f32_16x16x32_bf16 v[136:139], v[208:211], v[200:203], v[136:139]
    ds_read_b64_tr_b16 v[208:209], v5 offset:16
    ds_read_b64_tr_b16 v[210:211], v5 offset:912
    v_mfma_f32_16x16x32_bf16 v[20:23], v[212:215], v[188:191], v[20:23]
    ds_read_b64_tr_b16 v[236:237], v6 offset:64
    ds_read_b64_tr_b16 v[238:239], v6 offset:960
    v_mfma_f32_16x16x32_bf16 v[60:63], v[212:215], v[192:195], v[60:63]
    ds_read_b64_tr_b16 v[240:241], v6 offset:128
    ds_read_b64_tr_b16 v[242:243], v6 offset:1024
    v_mfma_f32_16x16x32_bf16 v[100:103], v[212:215], v[196:199], v[100:103]
    s_add_u32 m0, s42, 118320
    s_nop 0
    buffer_load_dwordx4 v2, s[12:15], s40 offen lds
    v_mfma_f32_16x16x32_bf16 v[140:143], v[212:215], v[200:203], v[140:143]
    ds_read_b64_tr_b16 v[212:213], v5 offset:32
    ds_read_b64_tr_b16 v[214:215], v5 offset:928
    v_mfma_f32_16x16x32_bf16 v[24:27], v[216:219], v[188:191], v[24:27]
    v_mfma_f32_16x16x32_bf16 v[64:67], v[216:219], v[192:195], v[64:67]
    v_mfma_f32_16x16x32_bf16 v[104:107], v[216:219], v[196:199], v[104:107]
    s_add_u32 m0, s42, 126016
    s_nop 0
    buffer_load_dwordx4 v2, s[16:19], s40 offen lds
    v_mfma_f32_16x16x32_bf16 v[144:147], v[216:219], v[200:203], v[144:147]
    ds_read_b64_tr_b16 v[216:217], v5 offset:48
    ds_read_b64_tr_b16 v[218:219], v5 offset:944
    v_mfma_f32_16x16x32_bf16 v[28:31], v[220:223], v[188:191], v[28:31]
    v_mfma_f32_16x16x32_bf16 v[68:71], v[220:223], v[192:195], v[68:71]
    v_mfma_f32_16x16x32_bf16 v[108:111], v[220:223], v[196:199], v[108:111]
    s_add_u32 m0, s42, 133696
    s_nop 0
    buffer_load_dwordx4 v10, s[60:63], s56 offen lds
    v_mfma_f32_16x16x32_bf16 v[148:151], v[220:223], v[200:203], v[148:151]
    ds_read_b64_tr_b16 v[220:221], v5 offset:64
    ds_read_b64_tr_b16 v[222:223], v5 offset:960
    v_mfma_f32_16x16x32_bf16 v[32:35], v[224:227], v[188:191], v[32:35]
    v_mfma_f32_16x16x32_bf16 v[72:75], v[224:227], v[192:195], v[72:75]
    v_mfma_f32_16x16x32_bf16 v[112:115], v[224:227], v[196:199], v[112:115]
    s_add_u32 s57, s57, 1
    s_and_b32 s57, s57, 31
    s_lshl_b32 s39, s57, 6
    s_mul_i32 s40, s57, 229376
    s_mul_i32 s56, s57, 196608
    v_mfma_f32_16x16x32_bf16 v[152:155], v[224:227], v[200:203], v[152:155]
    ds_read_b64_tr_b16 v[224:225], v5 offset:80
    ds_read_b64_tr_b16 v[226:227], v5 offset:976
    v_mfma_f32_16x16x32_bf16 v[36:39], v[228:231], v[188:191], v[36:39]
    v_mfma_f32_16x16x32_bf16 v[76:79], v[228:231], v[192:195], v[76:79]
    v_mfma_f32_16x16x32_bf16 v[116:119], v[228:231], v[196:199], v[116:119]
    v_mfma_f32_16x16x32_bf16 v[156:159], v[228:231], v[200:203], v[156:159]
    ds_read_b64_tr_b16 v[228:229], v5 offset:96
    ds_read_b64_tr_b16 v[230:231], v5 offset:992
    v_mfma_f32_16x16x32_bf16 v[40:43], v[232:235], v[188:191], v[40:43]
    v_mfma_f32_16x16x32_bf16 v[80:83], v[232:235], v[192:195], v[80:83]
    v_mfma_f32_16x16x32_bf16 v[120:123], v[232:235], v[196:199], v[120:123]
    v_mfma_f32_16x16x32_bf16 v[160:163], v[232:235], v[200:203], v[160:163]
    ds_read_b64_tr_b16 v[232:233], v6 offset:0
    ds_read_b64_tr_b16 v[234:235], v6 offset:896
    v_mfma_f32_16x16x32_bf16 v[44:47], v[244:247], v[188:191], v[44:47]
    v_mfma_f32_16x16x32_bf16 v[84:87], v[244:247], v[192:195], v[84:87]
    v_mfma_f32_16x16x32_bf16 v[124:127], v[244:247], v[196:199], v[124:127]
    v_mfma_f32_16x16x32_bf16 v[164:167], v[244:247], v[200:203], v[164:167]
    v_mfma_f32_16x16x32_bf16 v[48:51], v[188:191], v[248:251], v[48:51]
    v_mfma_f32_16x16x32_bf16 v[88:91], v[192:195], v[248:251], v[88:91]
    v_mfma_f32_16x16x32_bf16 v[128:131], v[196:199], v[248:251], v[128:131]
    v_mfma_f32_16x16x32_bf16 v[168:171], v[200:203], v[248:251], v[168:171]
    s_waitcnt lgkmcnt(0)
    s_mov_b32 s44, 6
L_k1_loop:
    s_waitcnt vmcnt(10)
    s_barrier
    v_add_u32 v3, 39440, v3
    v_add_u32 v5, 39440, v5
    v_add_u32 v6, 39440, v6
    v_mfma_f32_16x16x32_bf16 v[12:15], v[204:207], v[172:175], v[12:15]
    ds_read_b128 v[188:191], v3 offset:0
    v_mfma_f32_16x16x32_bf16 v[52:55], v[204:207], v[176:179], v[52:55]
    ds_read_b128 v[192:195], v3 offset:1024
    v_mfma_f32_16x16x32_bf16 v[92:95], v[204:207], v[180:183], v[92:95]
    s_add_u32 m0, s41, 0
    s_nop 0
    buffer_load_dwordx4 v1, s[8:11], s39 offen lds
    v_mfma_f32_16x16x32_bf16 v[132:135], v[204:207], v[184:187], v[132:135]
    ds_read_b64_tr_b16 v[204:205], v5 offset:0
    ds_read_b64_tr_b16 v[206:207], v5 offset:896
    v_mfma_f32_16x16x32_bf16 v[16:19], v[208:211], v[172:175], v[16:19]
    ds_read_b128 v[196:199], v3 offset:2048
    v_mfma_f32_16x16x32_bf16 v[56:59], v[208:211], v[176:179], v[56:59]
    ds_read_b128 v[200:203], v3 offset:3072
    v_mfma_f32_16x16x32_bf16 v[96:99], v[208:211], v[180:183], v[96:99]
    s_add_u32 m0, s41, 1024
    s_add_u32 s43, s39, 32768
    buffer_load_dwordx4 v1, s[8:11], s43 offen lds
    v_mfma_f32_16x16x32_bf16 v[136:139], v[208:211], v[184:187], v[136:139]
    ds_read_b64_tr_b16 v[208:209], v5 offset:16
    ds_read_b64_tr_b16 v[210:211], v5 offset:912
    v_mfma_f32_16x16x32_bf16 v[20:23], v[212:215], v[172:175], v[20:23]
    ds_read_b64_tr_b16 v[244:245], v6 offset:64
    ds_read_b64_tr_b16 v[246:247], v6 offset:960
    v_mfma_f32_16x16x32_bf16 v[60:63], v[212:215], v[176:179], v[60:63]
    ds_read_b64_tr_b16 v[248:249], v6 offset:128
    ds_read_b64_tr_b16 v[250:251], v6 offset:1024
    v_mfma_f32_16x16x32_bf16 v[100:103], v[212:215], v[180:183], v[100:103]
    s_add_u32 m0, s42, 0
    s_nop 0
    buffer_load_dwordx4 v2, s[12:15], s40 offen lds
    v_mfma_f32_16x16x32_bf16 v[140:143], v[212:215], v[184:187], v[140:143]
    ds_read_b64_tr_b16 v[212:213], v5 offset:32
    ds_read_b64_tr_b16 v[214:215], v5 offset:928
    v_mfma_f32_16x16x32_bf16 v[24:27], v[216:219], v[172:175], v[24:27]
    v_mfma_f32_16x16x32_bf16 v[64:67], v[216:219], v[176:179], v[64:67]
    v_mfma_f32_16x16x32_bf16 v[104:107], v[216:219], v[180:183], v[104:107]
    s_add_u32 m0, s42, 7696
    s_nop 0
    buffer_load_dwordx4 v2, s[16:19], s40 offen lds
    v_mfma_f32_16x16x32_bf16 v[144:147], v[216:219], v[184:187], v[144:147]
    ds_read_b64_tr_b16 v[216:217], v5 offset:48
    ds_read_b64_tr_b16 v[218:219], v5 offset:944
    v_mfma_f32_16x16x32_bf16 v[28:31], v[220:223], v[172:175], v[28:31]
    v_mfma_f32_16x16x32_bf16 v[68:71], v[220:223], v[176:179], v[68:71]
    v_mfma_f32_16x16x32_bf16 v[108:111], v[220:223], v[180:183], v[108:111]
    s_add_u32 m0, s42, 15376
    s_nop 0
    buffer_load_dwordx4 v10, s[60:63], s56 offen lds
    v_mfma_f32_16x16x32_bf16 v[148:151], v[220:223], v[184:187], v[148:151]
    ds_read_b64_tr_b16 v[220:221], v5 offset:64
    ds_read_b64_tr_b16 v[222:223], v5 offset:960
    v_mfma_f32_16x16x32_bf16 v[32:35], v[224:227], v[172:175], v[32:35]
    v_mfma_f32_16x16x32_bf16 v[72:75], v[224:227], v[176:179], v[72:75]
    v_mfma_f32_16x16x32_bf16 v[112:115], v[224:227], v[180:183], v[112:115]
    s_add_u32 s57, s57, 1
    s_and_b32 s57, s57, 31
    s_lshl_b32 s39, s57, 6
    s_mul_i32 s40, s57, 229376
    s_mul_i32 s56, s57, 196608
    v_mfma_f32_16x16x32_bf16 v[152:155], v[224:227], v[184:187], v[152:155]
    ds_read_b64_tr_b16 v[224:225], v5 offset:80
    ds_read_b64_tr_b16 v[226:227], v5 offset:976
    v_mfma_f32_16x16x32_bf16 v[36:39], v[228:231], v[172:175], v[36:39]
    v_mfma_f32_16x16x32_bf16 v[76:79], v[228:231], v[176:179], v[76:79]
    v_mfma_f32_16x16x32_bf16 v[116:119], v[228:231], v[180:183], v[116:119]
    v_mfma_f32_16x16x32_bf16 v[156:159], v[228:231], v[184:187], v[156:159]
    ds_read_b64_tr_b16 v[228:229], v5 offset:96
    ds_read_b64_tr_b16 v[230:231], v5 offset:992
    v_mfma_f32_16x16x32_bf16 v[40:43], v[232:235], v[172:175], v[40:43]
    v_mfma_f32_16x16x32_bf16 v[80:83], v[232:235], v[176:179], v[80:83]
    v_mfma_f32_16x16x32_bf16 v[120:123], v[232:235], v[180:183], v[120:123]
    v_mfma_f32_16x16x32_bf16 v[160:163], v[232:235], v[184:187], v[160:163]
    ds_read_b64_tr_b16 v[232:233], v6 offset:0
    ds_read_b64_tr_b16 v[234:235], v6 offset:896
    v_mfma_f32_16x16x32_bf16 v[44:47], v[236:239], v[172:175], v[44:47]
    v_mfma_f32_16x16x32_bf16 v[84:87], v[236:239], v[176:179], v[84:87]
    v_mfma_f32_16x16x32_bf16 v[124:127], v[236:239], v[180:183], v[124:127]
    v_mfma_f32_16x16x32_bf16 v[164:167], v[236:239], v[184:187], v[164:167]
    v_mfma_f32_16x16x32_bf16 v[48:51], v[172:175], v[240:243], v[48:51]
    v_mfma_f32_16x16x32_bf16 v[88:91], v[176:179], v[240:243], v[88:91]
    v_mfma_f32_16x16x32_bf16 v[128:131], v[180:183], v[240:243], v[128:131]
    v_mfma_f32_16x16x32_bf16 v[168:171], v[184:187], v[240:243], v[168:171]
    s_waitcnt lgkmcnt(0)
    s_waitcnt vmcnt(10)
    s_barrier
    v_add_u32 v3, 39440, v3
    v_add_u32 v5, 39440, v5
    v_add_u32 v6, 39440, v6
    v_mfma_f32_16x16x32_bf16 v[12:15], v[204:207], v[188:191], v[12:15]
    ds_read_b128 v[172:175], v3 offset:0
    v_mfma_f32_16x16x32_bf16 v[52:55], v[204:207], v[192:195], v[52:55]
    ds_read_b128 v[176:179], v3 offset:1024
    v_mfma_f32_16x16x32_bf16 v[92:95], v[204:207], v[196:199], v[92:95]
    s_add_u32 m0, s41, 39440
    s_nop 0
    buffer_load_dwordx4 v1, s[8:11], s39 offen lds
    v_mfma_f32_16x16x32_bf16 v[132:135], v[204:207], v[200:203], v[132:135]
    ds_read_b64_tr_b16 v[204:205], v5 offset:0
    ds_read_b64_tr_b16 v[206:207], v5 offset:896
    v_mfma_f32_16x16x32_bf16 v[16:19], v[208:211], v[188:191], v[16:19]
    ds_read_b128 v[180:183], v3 offset:2048
    v_mfma_f32_16x16x32_bf16 v[56:59], v[208:211], v[192:195], v[56:59]
    ds_read_b128 v[184:187], v3 offset:3072
    v_mfma_f32_16x16x32_bf16 v[96:99], v[208:211], v[196:199], v[96:99]
    s_add_u32 m0, s41, 40464
    s_add_u32 s43, s39, 32768
    buffer_load_dwordx4 v1, s[8:11], s43 offen lds
    v_mfma_f32_16x16x32_bf16 v[136:139], v[208:211], v[200:203], v[136:139]
    ds_read_b64_tr_b16 v[208:209], v5 offset:16
    ds_read_b64_tr_b16 v[210:211], v5 offset:912
    v_mfma_f32_16x16x32_bf16 v[20:23], v[212:215], v[188:191], v[20:23]
    ds_read_b64_tr_b16 v[236:237], v6 offset:64
    ds_read_b64_tr_b16 v[238:239], v6 offset:960
    v_mfma_f32_16x16x32_bf16 v[60:63], v[212:215], v[192:195], v[60:63]
    ds_read_b64_tr_b16 v[240:241], v6 offset:128
    ds_read_b64_tr_b16 v[242:243], v6 offset:1024
    v_mfma_f32_16x16x32_bf16 v[100:103], v[212:215], v[196:199], v[100:103]
    s_add_u32 m0, s42, 39440
    s_nop 0
    buffer_load_dwordx4 v2, s[12:15], s40 offen lds
    v_mfma_f32_16x16x32_bf16 v[140:143], v[212:215], v[200:203], v[140:143]
    ds_read_b64_tr_b16 v[212:213], v5 offset:32
    ds_read_b64_tr_b16 v[214:215], v5 offset:928
    v_mfma_f32_16x16x32_bf16 v[24:27], v[216:219], v[188:191], v[24:27]
    v_mfma_f32_16x16x32_bf16 v[64:67], v[216:219], v[192:195], v[64:67]
    v_mfma_f32_16x16x32_bf16 v[104:107], v[216:219], v[196:199], v[104:107]
    s_add_u32 m0, s42, 47136
    s_nop 0
    buffer_load_dwordx4 v2, s[16:19], s40 offen lds
    v_mfma_f32_16x16x32_bf16 v[144:147], v[216:219], v[200:203], v[144:147]
    ds_read_b64_tr_b16 v[216:217], v5 offset:48
    ds_read_b64_tr_b16 v[218:219], v5 offset:944
    v_mfma_f32_16x16x32_bf16 v[28:31], v[220:223], v[188:191], v[28:31]
    v_mfma_f32_16x16x32_bf16 v[68:71], v[220:223], v[192:195], v[68:71]
    v_mfma_f32_16x16x32_bf16 v[108:111], v[220:223], v[196:199], v[108:111]
    s_add_u32 m0, s42, 54816
    s_nop 0
    buffer_load_dwordx4 v10, s[60:63], s56 offen lds
    v_mfma_f32_16x16x32_bf16 v[148:151], v[220:223], v[200:203], v[148:151]
    ds_read_b64_tr_b16 v[220:221], v5 offset:64
    ds_read_b64_tr_b16 v[222:223], v5 offset:960
    v_mfma_f32_16x16x32_bf16 v[32:35], v[224:227], v[188:191], v[32:35]
    v_mfma_f32_16x16x32_bf16 v[72:75], v[224:227], v[192:195], v[72:75]
    v_mfma_f32_16x16x32_bf16 v[112:115], v[224:227], v[196:199], v[112:115]
    s_add_u32 s57, s57, 1
    s_and_b32 s57, s57, 31
    s_lshl_b32 s39, s57, 6
    s_mul_i32 s40, s57, 229376
    s_mul_i32 s56, s57, 196608
    v_mfma_f32_16x16x32_bf16 v[152:155], v[224:227], v[200:203], v[152:155]
    ds_read_b64_tr_b16 v[224:225], v5 offset:80
    ds_read_b64_tr_b16 v[226:227], v5 offset:976
    v_mfma_f32_16x16x32_bf16 v[36:39], v[228:231], v[188:191], v[36:39]
    v_mfma_f32_16x16x32_bf16 v[76:79], v[228:231], v[192:195], v[76:79]
    v_mfma_f32_16x16x32_bf16 v[116:119], v[228:231], v[196:199], v[116:119]
    v_mfma_f32_16x16x32_bf16 v[156:159], v[228:231], v[200:203], v[156:159]
    ds_read_b64_tr_b16 v[228:229], v5 offset:96
    ds_read_b64_tr_b16 v[230:231], v5 offset:992
    v_mfma_f32_16x16x32_bf16 v[40:43], v[232:235], v[188:191], v[40:43]
    v_mfma_f32_16x16x32_bf16 v[80:83], v[232:235], v[192:195], v[80:83]
    v_mfma_f32_16x16x32_bf16 v[120:123], v[232:235], v[196:199], v[120:123]
    v_mfma_f32_16x16x32_bf16 v[160:163], v[232:235], v[200:203], v[160:163]
    ds_read_b64_tr_b16 v[232:233], v6 offset:0
    ds_read_b64_tr_b16 v[234:235], v6 offset:896
    v_mfma_f32_16x16x32_bf16 v[44:47], v[244:247], v[188:191], v[44:47]
    v_mfma_f32_16x16x32_bf16 v[84:87], v[244:247], v[192:195], v[84:87]
    v_mfma_f32_16x16x32_bf16 v[124:127], v[244:247], v[196:199], v[124:127]
    v_mfma_f32_16x16x32_bf16 v[164:167], v[244:247], v[200:203], v[164:167]
    v_mfma_f32_16x16x32_bf16 v[48:51], v[188:191], v[248:251], v[48:51]
    v_mfma_f32_16x16x32_bf16 v[88:91], v[192:195], v[248:251], v[88:91]
    v_mfma_f32_16x16x32_bf16 v[128:131], v[196:199], v[248:251], v[128:131]
    v_mfma_f32_16x16x32_bf16 v[168:171], v[200:203], v[248:251], v[168:171]
    s_waitcnt lgkmcnt(0)
    s_waitcnt vmcnt(10)
    s_barrier
    v_add_u32 v3, 39440, v3
    v_add_u32 v5, 39440, v5
    v_add_u32 v6, 39440, v6
    v_mfma_f32_16x16x32_bf16 v[12:15], v[204:207], v[172:175], v[12:15]
    ds_read_b128 v[188:191], v3 offset:0
    v_mfma_f32_16x16x32_bf16 v[52:55], v[204:207], v[176:179], v[52:55]
    ds_read_b128 v[192:195], v3 offset:1024
    v_mfma_f32_16x16x32_bf16 v[92:95], v[204:207], v[180:183], v[92:95]
    s_add_u32 m0, s41, 78880
    s_nop 0
    buffer_load_dwordx4 v1, s[8:11], s39 offen lds
    v_mfma_f32_16x16x32_bf16 v[132:135], v[204:207], v[184:187], v[132:135]
    ds_read_b64_tr_b16 v[204:205], v5 offset:0
    ds_read_b64_tr_b16 v[206:207], v5 offset:896
    v_mfma_f32_16x16x32_bf16 v[16:19], v[208:211], v[172:175], v[16:19]
    ds_read_b128 v[196:199], v3 offset:2048
    v_mfma_f32_16x16x32_bf16 v[56:59], v[208:211], v[176:179], v[56:59]
    ds_read_b128 v[200:203], v3 offset:3072
    v_mfma_f32_16x16x32_bf16 v[96:99], v[208:211], v[180:183], v[96:99]
    s_add_u32 m0, s41, 79904
    s_add_u32 s43, s39, 32768
    buffer_load_dwordx4 v1, s[8:11], s43 offen lds
    v_mfma_f32_16x16x32_bf16 v[136:139], v[208:211], v[184:187], v[136:139]
    ds_read_b64_tr_b16 v[208:209], v5 offset:16
    ds_read_b64_tr_b16 v[210:211], v5 offset:912
    v_mfma_f32_16x16x32_bf16 v[20:23], v[212:215], v[172:175], v[20:23]
    ds_read_b64_tr_b16 v[244:245], v6 offset:64
    ds_read_b64_tr_b16 v[246:247], v6 offset:960
    v_mfma_f32_16x16x32_bf16 v[60:63], v[212:215], v[176:179], v[60:63]
    ds_read_b64_tr_b16 v[248:249], v6 offset:128
    ds_read_b64_tr_b16 v[250:251], v6 offset:1024
    v_mfma_f32_16x16x32_bf16 v[100:103], v[212:215], v[180:183], v[100:103]
    s_add_u32 m0, s42, 78880
    s_nop 0
    buffer_load_dwordx4 v2, s[12:15], s40 offen lds
    v_mfma_f32_16x16x32_bf16 v[140:143], v[212:215], v[184:187], v[140:143]
    ds_read_b64_tr_b16 v[212:213], v5 offset:32
    ds_read_b64_tr_b16 v[214:215], v5 offset:928
    v_mfma_f32_16x16x32_bf16 v[24:27], v[216:219], v[172:175], v[24:27]
    v_mfma_f32_16x16x32_bf16 v[64:67], v[216:219], v[176:179], v[64:67]
    v_mfma_f32_16x16x32_bf16 v[104:107], v[216:219], v[180:183], v[104:107]
    s_add_u32 m0, s42, 86576
    s_nop 0
    buffer_load_dwordx4 v2, s[16:19], s40 offen lds
    v_mfma_f32_16x16x32_bf16 v[144:147], v[216:219], v[184:187], v[144:147]
    ds_read_b64_tr_b16 v[216:217], v5 offset:48
    ds_read_b64_tr_b16 v[218:219], v5 offset:944
    v_mfma_f32_16x16x32_bf16 v[28:31], v[220:223], v[172:175], v[28:31]
    v_mfma_f32_16x16x32_bf16 v[68:71], v[220:223], v[176:179], v[68:71]
    v_mfma_f32_16x16x32_bf16 v[108:111], v[220:223], v[180:183], v[108:111]
    s_add_u32 m0, s42, 94256
    s_nop 0
    buffer_load_dwordx4 v10, s[60:63], s56 offen lds
    v_mfma_f32_16x16x32_bf16 v[148:151], v[220:223], v[184:187], v[148:151]
    ds_read_b64_tr_b16 v[220:221], v5 offset:64
    ds_read_b64_tr_b16 v[222:223], v5 offset:960
    v_mfma_f32_16x16x32_bf16 v[32:35], v[224:227], v[172:175], v[32:35]
    v_mfma_f32_16x16x32_bf16 v[72:75], v[224:227], v[176:179], v[72:75]
    v_mfma_f32_16x16x32_bf16 v[112:115], v[224:227], v[180:183], v[112:115]
    s_add_u32 s57, s57, 1
    s_and_b32 s57, s57, 31
    s_lshl_b32 s39, s57, 6
    s_mul_i32 s40, s57, 229376
    s_mul_i32 s56, s57, 196608
    v_mfma_f32_16x16x32_bf16 v[152:155], v[224:227], v[184:187], v[152:155]
    ds_read_b64_tr_b16 v[224:225], v5 offset:80
    ds_read_b64_tr_b16 v[226:227], v5 offset:976
    v_mfma_f32_16x16x32_bf16 v[36:39], v[228:231], v[172:175], v[36:39]
    v_mfma_f32_16x16x32_bf16 v[76:79], v[228:231], v[176:179], v[76:79]
    v_mfma_f32_16x16x32_bf16 v[116:119], v[228:231], v[180:183], v[116:119]
    v_mfma_f32_16x16x32_bf16 v[156:159], v[228:231], v[184:187], v[156:159]
    ds_read_b64_tr_b16 v[228:229], v5 offset:96
    ds_read_b64_tr_b16 v[230:231], v5 offset:992
    v_mfma_f32_16x16x32_bf16 v[40:43], v[232:235], v[172:175], v[40:43]
    v_mfma_f32_16x16x32_bf16 v[80:83], v[232:235], v[176:179], v[80:83]
    v_mfma_f32_16x16x32_bf16 v[120:123], v[232:235], v[180:183], v[120:123]
    v_mfma_f32_16x16x32_bf16 v[160:163], v[232:235], v[184:187], v[160:163]
    ds_read_b64_tr_b16 v[232:233], v6 offset:0
    ds_read_b64_tr_b16 v[234:235], v6 offset:896
    v_mfma_f32_16x16x32_bf16 v[44:47], v[236:239], v[172:175], v[44:47]
    v_mfma_f32_16x16x32_bf16 v[84:87], v[236:239], v[176:179], v[84:87]
    v_mfma_f32_16x16x32_bf16 v[124:127], v[236:239], v[180:183], v[124:127]
    v_mfma_f32_16x16x32_bf16 v[164:167], v[236:239], v[184:187], v[164:167]
    v_mfma_f32_16x16x32_bf16 v[48:51], v[172:175], v[240:243], v[48:51]
    v_mfma_f32_16x16x32_bf16 v[88:91], v[176:179], v[240:243], v[88:91]
    v_mfma_f32_16x16x32_bf16 v[128:131], v[180:183], v[240:243], v[128:131]
    v_mfma_f32_16x16x32_bf16 v[168:171], v[184:187], v[240:243], v[168:171]
    s_waitcnt lgkmcnt(0)
    s_waitcnt vmcnt(10)
    s_barrier
    v_subrev_u32 v3, 118320, v3
    v_subrev_u32 v5, 118320, v5
    v_subrev_u32 v6, 118320, v6
    v_mfma_f32_16x16x32_bf16 v[12:15], v[204:207], v[188:191], v[12:15]
    ds_read_b128 v[172:175], v3 offset:0
    v_mfma_f32_16x16x32_bf16 v[52:55], v[204:207], v[192:195], v[52:55]
    ds_read_b128 v[176:179], v3 offset:1024
    v_mfma_f32_16x16x32_bf16 v[92:95], v[204:207], v[196:199], v[92:95]
    s_add_u32 m0, s41, 118320
    s_nop 0
    buffer_load_dwordx4 v1, s[8:11], s39 offen lds
    v_mfma_f32_16x16x32_bf16 v[132:135], v[204:207], v[200:203], v[132:135]
    ds_read_b64_tr_b16 v[204:205], v5 offset:0
    ds_read_b64_tr_b16 v[206:207], v5 offset:896
    v_mfma_f32_16x16x32_bf16 v[16:19], v[208:211], v[188:191], v[16:19]
    ds_read_b128 v[180:183], v3 offset:2048
    v_mfma_f32_16x16x32_bf16 v[56:59], v[208:211], v[192:195], v[56:59]
    ds_read_b128 v[184:187], v3 offset:3072
    v_mfma_f32_16x16x32_bf16 v[96:99], v[208:211], v[196:199], v[96:99]
    s_add_u32 m0, s41, 119344
    s_add_u32 s43, s39, 32768
    buffer_load_dwordx4 v1, s[8:11], s43 offen lds
    v_mfma_f32_16x16x32_bf16 v[136:139], v[208:211], v[200:203], v[136:139]
    ds_read_b64_tr_b16 v[208:209], v5 offset:16
    ds_read_b64_tr_b16 v[210:211], v5 offset:912
    v_mfma_f32_16x16x32_bf16 v[20:23], v[212:215], v[188:191], v[20:23]
    ds_read_b64_tr_b16 v[236:237], v6 offset:64
    ds_read_b64_tr_b16 v[238:239], v6 offset:960
    v_mfma_f32_16x16x32_bf16 v[60:63], v[212:215], v[192:195], v[60:63]
    ds_read_b64_tr_b16 v[240:241], v6 offset:128
    ds_read_b64_tr_b16 v[242:243], v6 offset:1024
    v_mfma_f32_16x16x32_bf16 v[100:103], v[212:215], v[196:199], v[100:103]
    s_add_u32 m0, s42, 118320
    s_nop 0
    buffer_load_dwordx4 v2, s[12:15], s40 offen lds
    v_mfma_f32_16x16x32_bf16 v[140:143], v[212:215], v[200:203], v[140:143]
    ds_read_b64_tr_b16 v[212:213], v5 offset:32
    ds_read_b64_tr_b16 v[214:215], v5 offset:928
    v_mfma_f32_16x16x32_bf16 v[24:27], v[216:219], v[188:191], v[24:27]
    v_mfma_f32_16x16x32_bf16 v[64:67], v[216:219], v[192:195], v[64:67]
    v_mfma_f32_16x16x32_bf16 v[104:107], v[216:219], v[196:199], v[104:107]
    s_add_u32 m0, s42, 126016
    s_nop 0
    buffer_load_dwordx4 v2, s[16:19], s40 offen lds
    v_mfma_f32_16x16x32_bf16 v[144:147], v[216:219], v[200:203], v[144:147]
    ds_read_b64_tr_b16 v[216:217], v5 offset:48
    ds_read_b64_tr_b16 v[218:219], v5 offset:944
    v_mfma_f32_16x16x32_bf16 v[28:31], v[220:223], v[188:191], v[28:31]
    v_mfma_f32_16x16x32_bf16 v[68:71], v[220:223], v[192:195], v[68:71]
    v_mfma_f32_16x16x32_bf16 v[108:111], v[220:223], v[196:199], v[108:111]
    s_add_u32 m0, s42, 133696
    s_nop 0
    buffer_load_dwordx4 v10, s[60:63], s56 offen lds
    v_mfma_f32_16x16x32_bf16 v[148:151], v[220:223], v[200:203], v[148:151]
    ds_read_b64_tr_b16 v[220:221], v5 offset:64
    ds_read_b64_tr_b16 v[222:223], v5 offset:960
    v_mfma_f32_16x16x32_bf16 v[32:35], v[224:227], v[188:191], v[32:35]
    v_mfma_f32_16x16x32_bf16 v[72:75], v[224:227], v[192:195], v[72:75]
    v_mfma_f32_16x16x32_bf16 v[112:115], v[224:227], v[196:199], v[112:115]
    s_add_u32 s57, s57, 1
    s_and_b32 s57, s57, 31
    s_lshl_b32 s39, s57, 6
    s_mul_i32 s40, s57, 229376
    s_mul_i32 s56, s57, 196608
    v_mfma_f32_16x16x32_bf16 v[152:155], v[224:227], v[200:203], v[152:155]
    ds_read_b64_tr_b16 v[224:225], v5 offset:80
    ds_read_b64_tr_b16 v[226:227], v5 offset:976
    v_mfma_f32_16x16x32_bf16 v[36:39], v[228:231], v[188:191], v[36:39]
    v_mfma_f32_16x16x32_bf16 v[76:79], v[228:231], v[192:195], v[76:79]
    v_mfma_f32_16x16x32_bf16 v[116:119], v[228:231], v[196:199], v[116:119]
    v_mfma_f32_16x16x32_bf16 v[156:159], v[228:231], v[200:203], v[156:159]
    ds_read_b64_tr_b16 v[228:229], v5 offset:96
    ds_read_b64_tr_b16 v[230:231], v5 offset:992
    v_mfma_f32_16x16x32_bf16 v[40:43], v[232:235], v[188:191], v[40:43]
    v_mfma_f32_16x16x32_bf16 v[80:83], v[232:235], v[192:195], v[80:83]
    v_mfma_f32_16x16x32_bf16 v[120:123], v[232:235], v[196:199], v[120:123]
    v_mfma_f32_16x16x32_bf16 v[160:163], v[232:235], v[200:203], v[160:163]
    ds_read_b64_tr_b16 v[232:233], v6 offset:0
    ds_read_b64_tr_b16 v[234:235], v6 offset:896
    v_mfma_f32_16x16x32_bf16 v[44:47], v[244:247], v[188:191], v[44:47]
    v_mfma_f32_16x16x32_bf16 v[84:87], v[244:247], v[192:195], v[84:87]
    v_mfma_f32_16x16x32_bf16 v[124:127], v[244:247], v[196:199], v[124:127]
    v_mfma_f32_16x16x32_bf16 v[164:167], v[244:247], v[200:203], v[164:167]
    v_mfma_f32_16x16x32_bf16 v[48:51], v[188:191], v[248:251], v[48:51]
    v_mfma_f32_16x16x32_bf16 v[88:91], v[192:195], v[248:251], v[88:91]
    v_mfma_f32_16x16x32_bf16 v[128:131], v[196:199], v[248:251], v[128:131]
    v_mfma_f32_16x16x32_bf16 v[168:171], v[200:203], v[248:251], v[168:171]
    s_waitcnt lgkmcnt(0)
    s_sub_u32 s44, s44, 1
    s_cmp_lg_u32 s44, 0
    s_cbranch_scc1 L_k1_loop
    s_waitcnt vmcnt(10)
    s_barrier
    v_add_u32 v3, 39440, v3
    v_add_u32 v5, 39440, v5
    v_add_u32 v6, 39440, v6
    v_mfma_f32_16x16x32_bf16 v[12:15], v[204:207], v[172:175], v[12:15]
    ds_read_b128 v[188:191], v3 offset:0
    v_mfma_f32_16x16x32_bf16 v[52:55], v[204:207], v[176:179], v[52:55]
    ds_read_b128 v[192:195], v3 offset:1024
    v_mfma_f32_16x16x32_bf16 v[92:95], v[204:207], v[180:183], v[92:95]
    v_mfma_f32_16x16x32_bf16 v[132:135], v[204:207], v[184:187], v[132:135]
    ds_read_b64_tr_b16 v[204:205], v5 offset:0
    ds_read_b64_tr_b16 v[206:207], v5 offset:896
    v_mfma_f32_16x16x32_bf16 v[16:19], v[208:211], v[172:175], v[16:19]
    ds_read_b128 v[196:199], v3 offset:2048
    v_mfma_f32_16x16x32_bf16 v[56:59], v[208:211], v[176:179], v[56:59]
    ds_read_b128 v[200:203], v3 offset:3072
    v_mfma_f32_16x16x32_bf16 v[96:99], v[208:211], v[180:183], v[96:99]
    v_mfma_f32_16x16x32_bf16 v[136:139], v[208:211], v[184:187], v[136:139]
    ds_read_b64_tr_b16 v[208:209], v5 offset:16
    ds_read_b64_tr_b16 v[210:211], v5 offset:912
    v_mfma_f32_16x16x32_bf16 v[20:23], v[212:215], v[172:175], v[20:23]
    ds_read_b64_tr_b16 v[244:245], v6 offset:64
    ds_read_b64_tr_b16 v[246:247], v6 offset:960
    v_mfma_f32_16x16x32_bf16 v[60:63], v[212:215], v[176:179], v[60:63]
    ds_read_b64_tr_b16 v[248:249], v6 offset:128
    ds_read_b64_tr_b16 v[250:251], v6 offset:1024
    v_mfma_f32_16x16x32_bf16 v[100:103], v[212:215], v[180:183], v[100:103]
    v_mfma_f32_16x16x32_bf16 v[140:143], v[212:215], v[184:187], v[140:143]
    ds_read_b64_tr_b16 v[212:213], v5 offset:32
    ds_read_b64_tr_b16 v[214:215], v5 offset:928
    v_mfma_f32_16x16x32_bf16 v[24:27], v[216:219], v[172:175], v[24:27]
    v_mfma_f32_16x16x32_bf16 v[64:67], v[216:219], v[176:179], v[64:67]
    v_mfma_f32_16x16x32_bf16 v[104:107], v[216:219], v[180:183], v[104:107]
    v_mfma_f32_16x16x32_bf16 v[144:147], v[216:219], v[184:187], v[144:147]
    ds_read_b64_tr_b16 v[216:217], v5 offset:48
    ds_read_b64_tr_b16 v[218:219], v5 offset:944
    v_mfma_f32_16x16x32_bf16 v[28:31], v[220:223], v[172:175], v[28:31]
    v_mfma_f32_16x16x32_bf16 v[68:71], v[220:223], v[176:179], v[68:71]
    v_mfma_f32_16x16x32_bf16 v[108:111], v[220:223], v[180:183], v[108:111]
    v_mfma_f32_16x16x32_bf16 v[148:151], v[220:223], v[184:187], v[148:151]
    ds_read_b64_tr_b16 v[220:221], v5 offset:64
    ds_read_b64_tr_b16 v[222:223], v5 offset:960
    v_mfma_f32_16x16x32_bf16 v[32:35], v[224:227], v[172:175], v[32:35]
    v_mfma_f32_16x16x32_bf16 v[72:75], v[224:227], v[176:179], v[72:75]
    v_mfma_f32_16x16x32_bf16 v[112:115], v[224:227], v[180:183], v[112:115]
    v_mfma_f32_16x16x32_bf16 v[152:155], v[224:227], v[184:187], v[152:155]
    ds_read_b64_tr_b16 v[224:225], v5 offset:80
    ds_read_b64_tr_b16 v[226:227], v5 offset:976
    v_mfma_f32_16x16x32_bf16 v[36:39], v[228:231], v[172:175], v[36:39]
    v_mfma_f32_16x16x32_bf16 v[76:79], v[228:231], v[176:179], v[76:79]
    v_mfma_f32_16x16x32_bf16 v[116:119], v[228:231], v[180:183], v[116:119]
    v_mfma_f32_16x16x32_bf16 v[156:159], v[228:231], v[184:187], v[156:159]
    ds_read_b64_tr_b16 v[228:229], v5 offset:96
    ds_read_b64_tr_b16 v[230:231], v5 offset:992
    v_mfma_f32_16x16x32_bf16 v[40:43], v[232:235], v[172:175], v[40:43]
    v_mfma_f32_16x16x32_bf16 v[80:83], v[232:235], v[176:179], v[80:83]
    v_mfma_f32_16x16x32_bf16 v[120:123], v[232:235], v[180:183], v[120:123]
    v_mfma_f32_16x16x32_bf16 v[160:163], v[232:235], v[184:187], v[160:163]
    ds_read_b64_tr_b16 v[232:233], v6 offset:0
    ds_read_b64_tr_b16 v[234:235], v6 offset:896
    v_mfma_f32_16x16x32_bf16 v[44:47], v[236:239], v[172:175], v[44:47]
    v_mfma_f32_16x16x32_bf16 v[84:87], v[236:239], v[176:179], v[84:87]
    v_mfma_f32_16x16x32_bf16 v[124:127], v[236:239], v[180:183], v[124:127]
    v_mfma_f32_16x16x32_bf16 v[164:167], v[236:239], v[184:187], v[164:167]
    v_mfma_f32_16x16x32_bf16 v[48:51], v[172:175], v[240:243], v[48:51]
    v_mfma_f32_16x16x32_bf16 v[88:91], v[176:179], v[240:243], v[88:91]
    v_mfma_f32_16x16x32_bf16 v[128:131], v[180:183], v[240:243], v[128:131]
    v_mfma_f32_16x16x32_bf16 v[168:171], v[184:187], v[240:243], v[168:171]
    s_waitcnt lgkmcnt(0)
    s_waitcnt vmcnt(5)
    s_barrier
    v_add_u32 v3, 39440, v3
    v_add_u32 v5, 39440, v5
    v_add_u32 v6, 39440, v6
    v_mfma_f32_16x16x32_bf16 v[12:15], v[204:207], v[188:191], v[12:15]
    ds_read_b128 v[172:175], v3 offset:0
    v_mfma_f32_16x16x32_bf16 v[52:55], v[204:207], v[192:195], v[52:55]
    ds_read_b128 v[176:179], v3 offset:1024
    v_mfma_f32_16x16x32_bf16 v[92:95], v[204:207], v[196:199], v[92:95]
    v_mfma_f32_16x16x32_bf16 v[132:135], v[204:207], v[200:203], v[132:135]
    ds_read_b64_tr_b16 v[204:205], v5 offset:0
    ds_read_b64_tr_b16 v[206:207], v5 offset:896
    v_mfma_f32_16x16x32_bf16 v[16:19], v[208:211], v[188:191], v[16:19]
    ds_read_b128 v[180:183], v3 offset:2048
    v_mfma_f32_16x16x32_bf16 v[56:59], v[208:211], v[192:195], v[56:59]
    ds_read_b128 v[184:187], v3 offset:3072
    v_mfma_f32_16x16x32_bf16 v[96:99], v[208:211], v[196:199], v[96:99]
    v_mfma_f32_16x16x32_bf16 v[136:139], v[208:211], v[200:203], v[136:139]
    ds_read_b64_tr_b16 v[208:209], v5 offset:16
    ds_read_b64_tr_b16 v[210:211], v5 offset:912
    v_mfma_f32_16x16x32_bf16 v[20:23], v[212:215], v[188:191], v[20:23]
    ds_read_b64_tr_b16 v[236:237], v6 offset:64
    ds_read_b64_tr_b16 v[238:239], v6 offset:960
    v_mfma_f32_16x16x32_bf16 v[60:63], v[212:215], v[192:195], v[60:63]
    ds_read_b64_tr_b16 v[240:241], v6 offset:128
    ds_read_b64_tr_b16 v[242:243], v6 offset:1024
    v_mfma_f32_16x16x32_bf16 v[100:103], v[212:215], v[196:199], v[100:103]
    v_mfma_f32_16x16x32_bf16 v[140:143], v[212:215], v[200:203], v[140:143]
    ds_read_b64_tr_b16 v[212:213], v5 offset:32
    ds_read_b64_tr_b16 v[214:215], v5 offset:928
    v_mfma_f32_16x16x32_bf16 v[24:27], v[216:219], v[188:191], v[24:27]
    v_mfma_f32_16x16x32_bf16 v[64:67], v[216:219], v[192:195], v[64:67]
    v_mfma_f32_16x16x32_bf16 v[104:107], v[216:219], v[196:199], v[104:107]
    v_mfma_f32_16x16x32_bf16 v[144:147], v[216:219], v[200:203], v[144:147]
    ds_read_b64_tr_b16 v[216:217], v5 offset:48
    ds_read_b64_tr_b16 v[218:219], v5 offset:944
    v_mfma_f32_16x16x32_bf16 v[28:31], v[220:223], v[188:191], v[28:31]
    v_mfma_f32_16x16x32_bf16 v[68:71], v[220:223], v[192:195], v[68:71]
    v_mfma_f32_16x16x32_bf16 v[108:111], v[220:223], v[196:199], v[108:111]
    v_mfma_f32_16x16x32_bf16 v[148:151], v[220:223], v[200:203], v[148:151]
    ds_read_b64_tr_b16 v[220:221], v5 offset:64
    ds_read_b64_tr_b16 v[222:223], v5 offset:960
    v_mfma_f32_16x16x32_bf16 v[32:35], v[224:227], v[188:191], v[32:35]
    v_mfma_f32_16x16x32_bf16 v[72:75], v[224:227], v[192:195], v[72:75]
    v_mfma_f32_16x16x32_bf16 v[112:115], v[224:227], v[196:199], v[112:115]
    v_mfma_f32_16x16x32_bf16 v[152:155], v[224:227], v[200:203], v[152:155]
    ds_read_b64_tr_b16 v[224:225], v5 offset:80
    ds_read_b64_tr_b16 v[226:227], v5 offset:976
    v_mfma_f32_16x16x32_bf16 v[36:39], v[228:231], v[188:191], v[36:39]
    v_mfma_f32_16x16x32_bf16 v[76:79], v[228:231], v[192:195], v[76:79]
    v_mfma_f32_16x16x32_bf16 v[116:119], v[228:231], v[196:199], v[116:119]
    v_mfma_f32_16x16x32_bf16 v[156:159], v[228:231], v[200:203], v[156:159]
    ds_read_b64_tr_b16 v[228:229], v5 offset:96
    ds_read_b64_tr_b16 v[230:231], v5 offset:992
    v_mfma_f32_16x16x32_bf16 v[40:43], v[232:235], v[188:191], v[40:43]
    v_mfma_f32_16x16x32_bf16 v[80:83], v[232:235], v[192:195], v[80:83]
    v_mfma_f32_16x16x32_bf16 v[120:123], v[232:235], v[196:199], v[120:123]
    v_mfma_f32_16x16x32_bf16 v[160:163], v[232:235], v[200:203], v[160:163]
    ds_read_b64_tr_b16 v[232:233], v6 offset:0
    ds_read_b64_tr_b16 v[234:235], v6 offset:896
    v_mfma_f32_16x16x32_bf16 v[44:47], v[244:247], v[188:191], v[44:47]
    v_mfma_f32_16x16x32_bf16 v[84:87], v[244:247], v[192:195], v[84:87]
    v_mfma_f32_16x16x32_bf16 v[124:127], v[244:247], v[196:199], v[124:127]
    v_mfma_f32_16x16x32_bf16 v[164:167], v[244:247], v[200:203], v[164:167]
    v_mfma_f32_16x16x32_bf16 v[48:51], v[188:191], v[248:251], v[48:51]
    v_mfma_f32_16x16x32_bf16 v[88:91], v[192:195], v[248:251], v[88:91]
    v_mfma_f32_16x16x32_bf16 v[128:131], v[196:199], v[248:251], v[128:131]
    v_mfma_f32_16x16x32_bf16 v[168:171], v[200:203], v[248:251], v[168:171]
    s_waitcnt lgkmcnt(0)
    s_waitcnt vmcnt(0)
    s_barrier
    s_cmp_ge_u32 s34, 4
    s_cbranch_scc1 L_k1_noprio
    s_setprio 3
L_k1_noprio:
    v_add_u32 v3, 39440, v3
    v_add_u32 v5, 39440, v5
    v_add_u32 v6, 39440, v6
    v_mfma_f32_16x16x32_bf16 v[12:15], v[204:207], v[172:175], v[12:15]
    ds_read_b128 v[188:191], v3 offset:0
    v_mfma_f32_16x16x32_bf16 v[52:55], v[204:207], v[176:179], v[52:55]
    ds_read_b128 v[192:195], v3 offset:1024
    v_mfma_f32_16x16x32_bf16 v[92:95], v[204:207], v[180:183], v[92:95]
    v_mfma_f32_16x16x32_bf16 v[132:135], v[204:207], v[184:187], v[132:135]
    ds_read_b64_tr_b16 v[204:205], v5 offset:0
    ds_read_b64_tr_b16 v[206:207], v5 offset:896
    v_mfma_f32_16x16x32_bf16 v[16:19], v[208:211], v[172:175], v[16:19]
    ds_read_b128 v[196:199], v3 offset:2048
    v_mfma_f32_16x16x32_bf16 v[56:59], v[208:211], v[176:179], v[56:59]
    ds_read_b128 v[200:203], v3 offset:3072
    v_mfma_f32_16x16x32_bf16 v[96:99], v[208:211], v[180:183], v[96:99]
    v_mfma_f32_16x16x32_bf16 v[136:139], v[208:211], v[184:187], v[136:139]
    ds_read_b64_tr_b16 v[208:209], v5 offset:16
    ds_read_b64_tr_b16 v[210:211], v5 offset:912
    v_mfma_f32_16x16x32_bf16 v[20:23], v[212:215], v[172:175], v[20:23]
    ds_read_b64_tr_b16 v[244:245], v6 offset:64
    ds_read_b64_tr_b16 v[246:247], v6 offset:960
    v_mfma_f32_16x16x32_bf16 v[60:63], v[212:215], v[176:179], v[60:63]
    ds_read_b64_tr_b16 v[248:249], v6 offset:128
    ds_read_b64_tr_b16 v[250:251], v6 offset:1024
    v_mfma_f32_16x16x32_bf16 v[100:103], v[212:215], v[180:183], v[100:103]
    v_mfma_f32_16x16x32_bf16 v[140:143], v[212:215], v[184:187], v[140:143]
    ds_read_b64_tr_b16 v[212:213], v5 offset:32
    ds_read_b64_tr_b16 v[214:215], v5 offset:928
    v_mfma_f32_16x16x32_bf16 v[24:27], v[216:219], v[172:175], v[24:27]
    v_mfma_f32_16x16x32_bf16 v[64:67], v[216:219], v[176:179], v[64:67]
    v_mfma_f32_16x16x32_bf16 v[104:107], v[216:219], v[180:183], v[104:107]
    v_mfma_f32_16x16x32_bf16 v[144:147], v[216:219], v[184:187], v[144:147]
    ds_read_b64_tr_b16 v[216:217], v5 offset:48
    ds_read_b64_tr_b16 v[218:219], v5 offset:944
    v_mfma_f32_16x16x32_bf16 v[28:31], v[220:223], v[172:175], v[28:31]
    v_mfma_f32_16x16x32_bf16 v[68:71], v[220:223], v[176:179], v[68:71]
    v_mfma_f32_16x16x32_bf16 v[108:111], v[220:223], v[180:183], v[108:111]
    v_mfma_f32_16x16x32_bf16 v[148:151], v[220:223], v[184:187], v[148:151]
    ds_read_b64_tr_b16 v[220:221], v5 offset:64
    ds_read_b64_tr_b16 v[222:223], v5 offset:960
    v_mfma_f32_16x16x32_bf16 v[32:35], v[224:227], v[172:175], v[32:35]
    v_mfma_f32_16x16x32_bf16 v[72:75], v[224:227], v[176:179], v[72:75]
    v_mfma_f32_16x16x32_bf16 v[112:115], v[224:227], v[180:183], v[112:115]
    v_mfma_f32_16x16x32_bf16 v[152:155], v[224:227], v[184:187], v[152:155]
    ds_read_b64_tr_b16 v[224:225], v5 offset:80
    ds_read_b64_tr_b16 v[226:227], v5 offset:976
    v_mfma_f32_16x16x32_bf16 v[36:39], v[228:231], v[172:175], v[36:39]
    v_mfma_f32_16x16x32_bf16 v[76:79], v[228:231], v[176:179], v[76:79]
    v_mfma_f32_16x16x32_bf16 v[116:119], v[228:231], v[180:183], v[116:119]
    v_mfma_f32_16x16x32_bf16 v[156:159], v[228:231], v[184:187], v[156:159]
    ds_read_b64_tr_b16 v[228:229], v5 offset:96
    ds_read_b64_tr_b16 v[230:231], v5 offset:992
    v_mfma_f32_16x16x32_bf16 v[40:43], v[232:235], v[172:175], v[40:43]
    v_mfma_f32_16x16x32_bf16 v[80:83], v[232:235], v[176:179], v[80:83]
    v_mfma_f32_16x16x32_bf16 v[120:123], v[232:235], v[180:183], v[120:123]
    v_mfma_f32_16x16x32_bf16 v[160:163], v[232:235], v[184:187], v[160:163]
    ds_read_b64_tr_b16 v[232:233], v6 offset:0
    ds_read_b64_tr_b16 v[234:235], v6 offset:896
    v_mfma_f32_16x16x32_bf16 v[44:47], v[236:239], v[172:175], v[44:47]
    v_mfma_f32_16x16x32_bf16 v[84:87], v[236:239], v[176:179], v[84:87]
    v_mfma_f32_16x16x32_bf16 v[124:127], v[236:239], v[180:183], v[124:127]
    v_mfma_f32_16x16x32_bf16 v[164:167], v[236:239], v[184:187], v[164:167]
    v_mfma_f32_16x16x32_bf16 v[48:51], v[172:175], v[240:243], v[48:51]
    v_mfma_f32_16x16x32_bf16 v[88:91], v[176:179], v[240:243], v[88:91]
    v_mfma_f32_16x16x32_bf16 v[128:131], v[180:183], v[240:243], v[128:131]
    v_mfma_f32_16x16x32_bf16 v[168:171], v[184:187], v[240:243], v[168:171]
    s_waitcnt lgkmcnt(0)
    v_mfma_f32_16x16x32_bf16 v[12:15], v[204:207], v[188:191], v[12:15]
    v_mfma_f32_16x16x32_bf16 v[52:55], v[204:207], v[192:195], v[52:55]
    v_mfma_f32_16x16x32_bf16 v[92:95], v[204:207], v[196:199], v[92:95]
    v_mfma_f32_16x16x32_bf16 v[132:135], v[204:207], v[200:203], v[132:135]
    v_mfma_f32_16x16x32_bf16 v[16:19], v[208:211], v[188:191], v[16:19]
    v_mfma_f32_16x16x32_bf16 v[56:59], v[208:211], v[192:195], v[56:59]
    v_mfma_f32_16x16x32_bf16 v[96:99], v[208:211], v[196:199], v[96:99]
    v_mfma_f32_16x16x32_bf16 v[136:139], v[208:211], v[200:203], v[136:139]
    v_mfma_f32_16x16x32_bf16 v[20:23], v[212:215], v[188:191], v[20:23]
    v_mfma_f32_16x16x32_bf16 v[60:63], v[212:215], v[192:195], v[60:63]
    v_mfma_f32_16x16x32_bf16 v[100:103], v[212:215], v[196:199], v[100:103]
    v_mfma_f32_16x16x32_bf16 v[140:143], v[212:215], v[200:203], v[140:143]
    v_mfma_f32_16x16x32_bf16 v[24:27], v[216:219], v[188:191], v[24:27]
    v_mfma_f32_16x16x32_bf16 v[64:67], v[216:219], v[192:195], v[64:67]
    v_mfma_f32_16x16x32_bf16 v[104:107], v[216:219], v[196:199], v[104:107]
    v_mfma_f32_16x16x32_bf16 v[144:147], v[216:219], v[200:203], v[144:147]
    v_mfma_f32_16x16x32_bf16 v[28:31], v[220:223], v[188:191], v[28:31]
    v_mfma_f32_16x16x32_bf16 v[68:71], v[220:223], v[192:195], v[68:71]
    v_mfma_f32_16x16x32_bf16 v[108:111], v[220:223], v[196:199], v[108:111]
    v_mfma_f32_16x16x32_bf16 v[148:151], v[220:223], v[200:203], v[148:151]
    v_mfma_f32_16x16x32_bf16 v[32:35], v[224:227], v[188:191], v[32:35]
    v_mfma_f32_16x16x32_bf16 v[72:75], v[224:227], v[192:195], v[72:75]
    v_mfma_f32_16x16x32_bf16 v[112:115], v[224:227], v[196:199], v[112:115]
    v_mfma_f32_16x16x32_bf16 v[152:155], v[224:227], v[200:203], v[152:155]
    v_mfma_f32_16x16x32_bf16 v[36:39], v[228:231], v[188:191], v[36:39]
    v_mfma_f32_16x16x32_bf16 v[76:79], v[228:231], v[192:195], v[76:79]
    v_mfma_f32_16x16x32_bf16 v[116:119], v[228:231], v[196:199], v[116:119]
    v_mfma_f32_16x16x32_bf16 v[156:159], v[228:231], v[200:203], v[156:159]
    v_mfma_f32_16x16x32_bf16 v[40:43], v[232:235], v[188:191], v[40:43]
    v_mfma_f32_16x16x32_bf16 v[80:83], v[232:235], v[192:195], v[80:83]
    v_mfma_f32_16x16x32_bf16 v[120:123], v[232:235], v[196:199], v[120:123]
    v_mfma_f32_16x16x32_bf16 v[160:163], v[232:235], v[200:203], v[160:163]
    v_mfma_f32_16x16x32_bf16 v[44:47], v[244:247], v[188:191], v[44:47]
    v_mfma_f32_16x16x32_bf16 v[84:87], v[244:247], v[192:195], v[84:87]
    v_mfma_f32_16x16x32_bf16 v[124:127], v[244:247], v[196:199], v[124:127]
    v_mfma_f32_16x16x32_bf16 v[164:167], v[244:247], v[200:203], v[164:167]
    v_mfma_f32_16x16x32_bf16 v[48:51], v[188:191], v[248:251], v[48:51]
    v_mfma_f32_16x16x32_bf16 v[88:91], v[192:195], v[248:251], v[88:91]
    v_mfma_f32_16x16x32_bf16 v[128:131], v[196:199], v[248:251], v[128:131]
    v_mfma_f32_16x16x32_bf16 v[168:171], v[200:203], v[248:251], v[168:171]
    v_lshlrev_b32 v7, 5, v0
    buffer_load_dwordx4 v[220:223], v7, s[8:11], s55 offen
    buffer_load_dwordx4 v[224:227], v7, s[8:11], s55 offen offset:16
    buffer_load_dwordx4 v[228:231], v7, s[64:67], 0 offen
    buffer_load_dwordx4 v[232:235], v7, s[64:67], 0 offen offset:16
    v_and_b32 v7, 15, v0
    v_lshlrev_b32 v1, 4, v7
    v_bfe_u32 v8, v0, 4, 1
    v_lshl_add_u32 v1, v8, 3, v1
    v_lshrrev_b32 v8, 5, v0
    s_mov_b32 s45, 147456
    v_mul_lo_u32 v8, v8, s45
    v_add_u32 v1, v1, v8
    s_lshl_b32 s46, s37, 4
    s_lshl_b32 s47, s35, 2
    s_add_u32 s46, s46, s47
    s_mul_i32 s46, s46, 147456
    s_mul_i32 s47, s38, 14
    s_mul_i32 s45, s36, 7
    s_add_u32 s47, s47, s45
    s_lshl_b32 s47, s47, 8
    s_add_u32 s46, s46, s47
    s_add_u32 s46, s46, 12582912
    s_add_u32 s47, s46, 294912
    s_mov_b32 s52, 0xc0135761
    s_mov_b32 s53, 0xbdd2d3e8
    v_mov_b32 v2, s52
    v_mov_b32 v240, s52
    v_mov_b32 v241, s52
    v_mov_b32 v242, s53
    v_mov_b32 v243, s53
    v_mov_b32 v244, 1.0
    v_mov_b32 v245, 1.0
    s_lshl_b32 s45, s38, 17
    s_lshl_b32 s48, s37, 3
    s_lshl_b32 s49, s35, 1
    s_add_u32 s48, s48, s49
    s_lshl_b32 s48, s48, 11
    s_add_u32 s45, s45, s48
    s_lshl_b32 s48, s36, 10
    s_add_u32 s48, s48, s45
    s_add_u32 s49, s48, 4194304
    s_lshl_b32 s50, s36, 8
    s_add_u32 s50, s50, s45
    s_add_u32 s50, s50, 8388608
    v_lshlrev_b32 v7, 4, v7
    v_bfe_u32 v9, v0, 4, 1
    v_lshrrev_b32 v8, 5, v0
    v_lshl_add_u32 v3, v9, 8, v7
    v_lshl_add_u32 v5, v8, 0, v3
    v_lshl_add_u32 v3, v8, 9, v3
    v_lshl_add_u32 v4, v9, 9, v7
    v_lshl_add_u32 v4, v8, 10, v4
    s_mov_b32 s45, 147456
    v_mul_lo_u32 v5, v8, s45
    v_add_u32 v5, v5, v7
    v_lshl_add_u32 v5, v9, 8, v5
    s_mov_b32 s51, 0x3e8293ee
    v_mul_f32 v40, s51, v40
    v_mul_f32 v41, s51, v41
    v_mul_f32 v42, s51, v42
    v_mul_f32 v43, s51, v43
    v_cvt_pk_bf16_f32 v204, v40, v41
    v_cvt_pk_bf16_f32 v205, v42, v43
    v_mul_f32 v80, s51, v80
    v_mul_f32 v81, s51, v81
    v_mul_f32 v82, s51, v82
    v_mul_f32 v83, s51, v83
    v_cvt_pk_bf16_f32 v206, v80, v81
    v_cvt_pk_bf16_f32 v207, v82, v83
    s_nop 0
    v_permlane16_swap_b32 v204, v206
    v_permlane16_swap_b32 v205, v207
    buffer_store_dwordx4 v[204:207], v3, s[20:23], s48 offen offset:0 nt
    v_cvt_pk_bf16_f32 v208, v44, v45
    v_cvt_pk_bf16_f32 v209, v46, v47
    v_cvt_pk_bf16_f32 v210, v84, v85
    v_cvt_pk_bf16_f32 v211, v86, v87
    s_nop 0
    v_permlane16_swap_b32 v208, v210
    v_permlane16_swap_b32 v209, v211
    buffer_store_dwordx4 v[208:211], v3, s[20:23], s49 offen offset:0 nt
    v_cvt_pk_bf16_f32 v212, v48, v49
    v_cvt_pk_bf16_f32 v213, v50, v51
    v_cvt_pk_bf16_f32 v214, v88, v89
    v_cvt_pk_bf16_f32 v215, v90, v91
    s_nop 0
    v_permlane32_swap_b32 v212, v214
    v_permlane32_swap_b32 v213, v215
    buffer_store_dwordx4 v[212:215], v4, s[20:23], s50 offen offset:0 nt
    v_mul_f32 v120, s51, v120
    v_mul_f32 v121, s51, v121
    v_mul_f32 v122, s51, v122
    v_mul_f32 v123, s51, v123
    v_cvt_pk_bf16_f32 v216, v120, v121
    v_cvt_pk_bf16_f32 v217, v122, v123
    v_mul_f32 v160, s51, v160
    v_mul_f32 v161, s51, v161
    v_mul_f32 v162, s51, v162
    v_mul_f32 v163, s51, v163
    v_cvt_pk_bf16_f32 v218, v160, v161
    v_cvt_pk_bf16_f32 v219, v162, v163
    s_nop 0
    v_permlane16_swap_b32 v216, v218
    v_permlane16_swap_b32 v217, v219
    buffer_store_dwordx4 v[216:219], v3, s[20:23], s48 offen offset:2048 nt
    v_cvt_pk_bf16_f32 v204, v124, v125
    v_cvt_pk_bf16_f32 v205, v126, v127
    v_cvt_pk_bf16_f32 v206, v164, v165
    v_cvt_pk_bf16_f32 v207, v166, v167
    s_nop 0
    v_permlane16_swap_b32 v204, v206
    v_permlane16_swap_b32 v205, v207
    buffer_store_dwordx4 v[204:207], v3, s[20:23], s49 offen offset:2048 nt
    v_cvt_pk_bf16_f32 v208, v128, v129
    v_cvt_pk_bf16_f32 v209, v130, v131
    v_cvt_pk_bf16_f32 v210, v168, v169
    v_cvt_pk_bf16_f32 v211, v170, v171
    s_nop 0
    v_permlane32_swap_b32 v208, v210
    v_permlane32_swap_b32 v209, v211
    buffer_store_dwordx4 v[208:211], v4, s[20:23], s50 offen offset:2048 nt
    v_permlane32_swap_b32 v12, v52
    v_permlane32_swap_b32 v13, v53
    v_permlane32_swap_b32 v14, v54
    v_permlane32_swap_b32 v15, v55
    v_pk_mul_f32 v[172:173], v[12:13], v[12:13]
    v_pk_mul_f32 v[174:175], v[14:15], v[14:15]
    v_pk_fma_f32 v[172:173], v[172:173], v[242:243], v[240:241]
    v_pk_fma_f32 v[174:175], v[174:175], v[242:243], v[240:241]
    v_pk_mul_f32 v[172:173], v[172:173], v[12:13]
    v_pk_mul_f32 v[174:175], v[174:175], v[14:15]
    v_exp_f32 v172, v172
    v_exp_f32 v173, v173
    v_exp_f32 v174, v174
    v_exp_f32 v175, v175
    v_pk_mul_f32 v[176:177], v[12:13], v[52:53]
    v_pk_mul_f32 v[178:179], v[14:15], v[54:55]
    v_pk_add_f32 v[172:173], v[172:173], v[244:245]
    v_pk_add_f32 v[174:175], v[174:175], v[244:245]
    v_rcp_f32 v172, v172
    v_rcp_f32 v173, v173
    v_rcp_f32 v174, v174
    v_rcp_f32 v175, v175
    v_pk_mul_f32 v[172:173], v[172:173], v[176:177]
    v_pk_mul_f32 v[174:175], v[174:175], v[178:179]
    v_cvt_pk_bf16_f32 v188, v172, v173
    v_cvt_pk_bf16_f32 v189, v174, v175
    v_permlane32_swap_b32 v16, v56
    v_permlane32_swap_b32 v17, v57
    v_permlane32_swap_b32 v18, v58
    v_permlane32_swap_b32 v19, v59
    v_pk_mul_f32 v[180:181], v[16:17], v[16:17]
    v_pk_mul_f32 v[182:183], v[18:19], v[18:19]
    v_pk_fma_f32 v[180:181], v[180:181], v[242:243], v[240:241]
    v_pk_fma_f32 v[182:183], v[182:183], v[242:243], v[240:241]
    v_pk_mul_f32 v[180:181], v[180:181], v[16:17]
    v_pk_mul_f32 v[182:183], v[182:183], v[18:19]
    v_exp_f32 v180, v180
    v_exp_f32 v181, v181
    v_exp_f32 v182, v182
    v_exp_f32 v183, v183
    v_pk_mul_f32 v[184:185], v[16:17], v[56:57]
    v_pk_mul_f32 v[186:187], v[18:19], v[58:59]
    v_pk_add_f32 v[180:181], v[180:181], v[244:245]
    v_pk_add_f32 v[182:183], v[182:183], v[244:245]
    v_rcp_f32 v180, v180
    v_rcp_f32 v181, v181
    v_rcp_f32 v182, v182
    v_rcp_f32 v183, v183
    v_pk_mul_f32 v[180:181], v[180:181], v[184:185]
    v_pk_mul_f32 v[182:183], v[182:183], v[186:187]
    v_cvt_pk_bf16_f32 v190, v180, v181
    v_cvt_pk_bf16_f32 v191, v182, v183
    s_nop 0
    v_permlane16_swap_b32 v188, v190
    v_permlane16_swap_b32 v189, v191
    buffer_store_dwordx4 v[188:191], v5, s[20:23], s46 offen offset:0 nt
    v_permlane32_swap_b32 v20, v60
    v_permlane32_swap_b32 v21, v61
    v_permlane32_swap_b32 v22, v62
    v_permlane32_swap_b32 v23, v63
    v_pk_mul_f32 v[172:173], v[20:21], v[20:21]
    v_pk_mul_f32 v[174:175], v[22:23], v[22:23]
    v_pk_fma_f32 v[172:173], v[172:173], v[242:243], v[240:241]
    v_pk_fma_f32 v[174:175], v[174:175], v[242:243], v[240:241]
    v_pk_mul_f32 v[172:173], v[172:173], v[20:21]
    v_pk_mul_f32 v[174:175], v[174:175], v[22:23]
    v_exp_f32 v172, v172
    v_exp_f32 v173, v173
    v_exp_f32 v174, v174
    v_exp_f32 v175, v175
    v_pk_mul_f32 v[176:177], v[20:21], v[60:61]
    v_pk_mul_f32 v[178:179], v[22:23], v[62:63]
    v_pk_add_f32 v[172:173], v[172:173], v[244:245]
    v_pk_add_f32 v[174:175], v[174:175], v[244:245]
    v_rcp_f32 v172, v172
    v_rcp_f32 v173, v173
    v_rcp_f32 v174, v174
    v_rcp_f32 v175, v175
    v_pk_mul_f32 v[172:173], v[172:173], v[176:177]
    v_pk_mul_f32 v[174:175], v[174:175], v[178:179]
    v_cvt_pk_bf16_f32 v192, v172, v173
    v_cvt_pk_bf16_f32 v193, v174, v175
    v_permlane32_swap_b32 v24, v64
    v_permlane32_swap_b32 v25, v65
    v_permlane32_swap_b32 v26, v66
    v_permlane32_swap_b32 v27, v67
    v_pk_mul_f32 v[180:181], v[24:25], v[24:25]
    v_pk_mul_f32 v[182:183], v[26:27], v[26:27]
    v_pk_fma_f32 v[180:181], v[180:181], v[242:243], v[240:241]
    v_pk_fma_f32 v[182:183], v[182:183], v[242:243], v[240:241]
    v_pk_mul_f32 v[180:181], v[180:181], v[24:25]
    v_pk_mul_f32 v[182:183], v[182:183], v[26:27]
    v_exp_f32 v180, v180
    v_exp_f32 v181, v181
    v_exp_f32 v182, v182
    v_exp_f32 v183, v183
    v_pk_mul_f32 v[184:185], v[24:25], v[64:65]
    v_pk_mul_f32 v[186:187], v[26:27], v[66:67]
    v_pk_add_f32 v[180:181], v[180:181], v[244:245]
    v_pk_add_f32 v[182:183], v[182:183], v[244:245]
    v_rcp_f32 v180, v180
    v_rcp_f32 v181, v181
    v_rcp_f32 v182, v182
    v_rcp_f32 v183, v183
    v_pk_mul_f32 v[180:181], v[180:181], v[184:185]
    v_pk_mul_f32 v[182:183], v[182:183], v[186:187]
    v_cvt_pk_bf16_f32 v194, v180, v181
    v_cvt_pk_bf16_f32 v195, v182, v183
    s_nop 0
    v_permlane16_swap_b32 v192, v194
    v_permlane16_swap_b32 v193, v195
    buffer_store_dwordx4 v[192:195], v5, s[20:23], s46 offen offset:512 nt
    v_permlane32_swap_b32 v28, v68
    v_permlane32_swap_b32 v29, v69
    v_permlane32_swap_b32 v30, v70
    v_permlane32_swap_b32 v31, v71
    v_pk_mul_f32 v[172:173], v[28:29], v[28:29]
    v_pk_mul_f32 v[174:175], v[30:31], v[30:31]
    v_pk_fma_f32 v[172:173], v[172:173], v[242:243], v[240:241]
    v_pk_fma_f32 v[174:175], v[174:175], v[242:243], v[240:241]
    v_pk_mul_f32 v[172:173], v[172:173], v[28:29]
    v_pk_mul_f32 v[174:175], v[174:175], v[30:31]
    v_exp_f32 v172, v172
    v_exp_f32 v173, v173
    v_exp_f32 v174, v174
    v_exp_f32 v175, v175
    v_pk_mul_f32 v[176:177], v[28:29], v[68:69]
    v_pk_mul_f32 v[178:179], v[30:31], v[70:71]
    v_pk_add_f32 v[172:173], v[172:173], v[244:245]
    v_pk_add_f32 v[174:175], v[174:175], v[244:245]
    v_rcp_f32 v172, v172
    v_rcp_f32 v173, v173
    v_rcp_f32 v174, v174
    v_rcp_f32 v175, v175
    v_pk_mul_f32 v[172:173], v[172:173], v[176:177]
    v_pk_mul_f32 v[174:175], v[174:175], v[178:179]
    v_cvt_pk_bf16_f32 v188, v172, v173
    v_cvt_pk_bf16_f32 v189, v174, v175
    v_permlane32_swap_b32 v32, v72
    v_permlane32_swap_b32 v33, v73
    v_permlane32_swap_b32 v34, v74
    v_permlane32_swap_b32 v35, v75
    v_pk_mul_f32 v[180:181], v[32:33], v[32:33]
    v_pk_mul_f32 v[182:183], v[34:35], v[34:35]
    v_pk_fma_f32 v[180:181], v[180:181], v[242:243], v[240:241]
    v_pk_fma_f32 v[182:183], v[182:183], v[242:243], v[240:241]
    v_pk_mul_f32 v[180:181], v[180:181], v[32:33]
    v_pk_mul_f32 v[182:183], v[182:183], v[34:35]
    v_exp_f32 v180, v180
    v_exp_f32 v181, v181
    v_exp_f32 v182, v182
    v_exp_f32 v183, v183
    v_pk_mul_f32 v[184:185], v[32:33], v[72:73]
    v_pk_mul_f32 v[186:187], v[34:35], v[74:75]
    v_pk_add_f32 v[180:181], v[180:181], v[244:245]
    v_pk_add_f32 v[182:183], v[182:183], v[244:245]
    v_rcp_f32 v180, v180
    v_rcp_f32 v181, v181
    v_rcp_f32 v182, v182
    v_rcp_f32 v183, v183
    v_pk_mul_f32 v[180:181], v[180:181], v[184:185]
    v_pk_mul_f32 v[182:183], v[182:183], v[186:187]
    v_cvt_pk_bf16_f32 v190, v180, v181
    v_cvt_pk_bf16_f32 v191, v182, v183
    s_nop 0
    v_permlane16_swap_b32 v188, v190
    v_permlane16_swap_b32 v189, v191
    buffer_store_dwordx4 v[188:191], v5, s[20:23], s46 offen offset:1024 nt
    v_permlane32_swap_b32 v36, v76
    v_permlane32_swap_b32 v37, v77
    v_permlane32_swap_b32 v38, v78
    v_permlane32_swap_b32 v39, v79
    v_pk_mul_f32 v[172:173], v[36:37], v[36:37]
    v_pk_mul_f32 v[174:175], v[38:39], v[38:39]
    v_pk_fma_f32 v[172:173], v[172:173], v[242:243], v[240:241]
    v_pk_fma_f32 v[174:175], v[174:175], v[242:243], v[240:241]
    v_pk_mul_f32 v[172:173], v[172:173], v[36:37]
    v_pk_mul_f32 v[174:175], v[174:175], v[38:39]
    v_exp_f32 v172, v172
    v_exp_f32 v173, v173
    v_exp_f32 v174, v174
    v_exp_f32 v175, v175
    v_pk_mul_f32 v[176:177], v[36:37], v[76:77]
    v_pk_mul_f32 v[178:179], v[38:39], v[78:79]
    v_pk_add_f32 v[172:173], v[172:173], v[244:245]
    v_pk_add_f32 v[174:175], v[174:175], v[244:245]
    v_rcp_f32 v172, v172
    v_rcp_f32 v173, v173
    v_rcp_f32 v174, v174
    v_rcp_f32 v175, v175
    v_pk_mul_f32 v[172:173], v[172:173], v[176:177]
    v_pk_mul_f32 v[174:175], v[174:175], v[178:179]
    v_cvt_pk_bf16_f32 v192, v172, v173
    v_cvt_pk_bf16_f32 v193, v174, v175
    buffer_store_dwordx2 v[192:193], v1, s[20:23], s46 offen offset:1536 nt
    v_permlane32_swap_b32 v92, v132
    v_permlane32_swap_b32 v93, v133
    v_permlane32_swap_b32 v94, v134
    v_permlane32_swap_b32 v95, v135
    v_pk_mul_f32 v[172:173], v[92:93], v[92:93]
    v_pk_mul_f32 v[174:175], v[94:95], v[94:95]
    v_pk_fma_f32 v[172:173], v[172:173], v[242:243], v[240:241]
    v_pk_fma_f32 v[174:175], v[174:175], v[242:243], v[240:241]
    v_pk_mul_f32 v[172:173], v[172:173], v[92:93]
    v_pk_mul_f32 v[174:175], v[174:175], v[94:95]
    v_exp_f32 v172, v172
    v_exp_f32 v173, v173
    v_exp_f32 v174, v174
    v_exp_f32 v175, v175
    v_pk_mul_f32 v[176:177], v[92:93], v[132:133]
    v_pk_mul_f32 v[178:179], v[94:95], v[134:135]
    v_pk_add_f32 v[172:173], v[172:173], v[244:245]
    v_pk_add_f32 v[174:175], v[174:175], v[244:245]
    v_rcp_f32 v172, v172
    v_rcp_f32 v173, v173
    v_rcp_f32 v174, v174
    v_rcp_f32 v175, v175
    v_pk_mul_f32 v[172:173], v[172:173], v[176:177]
    v_pk_mul_f32 v[174:175], v[174:175], v[178:179]
    v_cvt_pk_bf16_f32 v188, v172, v173
    v_cvt_pk_bf16_f32 v189, v174, v175
    v_permlane32_swap_b32 v96, v136
    v_permlane32_swap_b32 v97, v137
    v_permlane32_swap_b32 v98, v138
    v_permlane32_swap_b32 v99, v139
    v_pk_mul_f32 v[180:181], v[96:97], v[96:97]
    v_pk_mul_f32 v[182:183], v[98:99], v[98:99]
    v_pk_fma_f32 v[180:181], v[180:181], v[242:243], v[240:241]
    v_pk_fma_f32 v[182:183], v[182:183], v[242:243], v[240:241]
    v_pk_mul_f32 v[180:181], v[180:181], v[96:97]
    v_pk_mul_f32 v[182:183], v[182:183], v[98:99]
    v_exp_f32 v180, v180
    v_exp_f32 v181, v181
    v_exp_f32 v182, v182
    v_exp_f32 v183, v183
    v_pk_mul_f32 v[184:185], v[96:97], v[136:137]
    v_pk_mul_f32 v[186:187], v[98:99], v[138:139]
    v_pk_add_f32 v[180:181], v[180:181], v[244:245]
    v_pk_add_f32 v[182:183], v[182:183], v[244:245]
    v_rcp_f32 v180, v180
    v_rcp_f32 v181, v181
    v_rcp_f32 v182, v182
    v_rcp_f32 v183, v183
    v_pk_mul_f32 v[180:181], v[180:181], v[184:185]
    v_pk_mul_f32 v[182:183], v[182:183], v[186:187]
    v_cvt_pk_bf16_f32 v190, v180, v181
    v_cvt_pk_bf16_f32 v191, v182, v183
    s_nop 0
    v_permlane16_swap_b32 v188, v190
    v_permlane16_swap_b32 v189, v191
    buffer_store_dwordx4 v[188:191], v5, s[20:23], s47 offen offset:0 nt
    v_permlane32_swap_b32 v100, v140
    v_permlane32_swap_b32 v101, v141
    v_permlane32_swap_b32 v102, v142
    v_permlane32_swap_b32 v103, v143
    v_pk_mul_f32 v[172:173], v[100:101], v[100:101]
    v_pk_mul_f32 v[174:175], v[102:103], v[102:103]
    v_pk_fma_f32 v[172:173], v[172:173], v[242:243], v[240:241]
    v_pk_fma_f32 v[174:175], v[174:175], v[242:243], v[240:241]
    v_pk_mul_f32 v[172:173], v[172:173], v[100:101]
    v_pk_mul_f32 v[174:175], v[174:175], v[102:103]
    v_exp_f32 v172, v172
    v_exp_f32 v173, v173
    v_exp_f32 v174, v174
    v_exp_f32 v175, v175
    v_pk_mul_f32 v[176:177], v[100:101], v[140:141]
    v_pk_mul_f32 v[178:179], v[102:103], v[142:143]
    v_pk_add_f32 v[172:173], v[172:173], v[244:245]
    v_pk_add_f32 v[174:175], v[174:175], v[244:245]
    v_rcp_f32 v172, v172
    v_rcp_f32 v173, v173
    v_rcp_f32 v174, v174
    v_rcp_f32 v175, v175
    v_pk_mul_f32 v[172:173], v[172:173], v[176:177]
    v_pk_mul_f32 v[174:175], v[174:175], v[178:179]
    v_cvt_pk_bf16_f32 v192, v172, v173
    v_cvt_pk_bf16_f32 v193, v174, v175
    v_permlane32_swap_b32 v104, v144
    v_permlane32_swap_b32 v105, v145
    v_permlane32_swap_b32 v106, v146
    v_permlane32_swap_b32 v107, v147
    v_pk_mul_f32 v[180:181], v[104:105], v[104:105]
    v_pk_mul_f32 v[182:183], v[106:107], v[106:107]
    v_pk_fma_f32 v[180:181], v[180:181], v[242:243], v[240:241]
    v_pk_fma_f32 v[182:183], v[182:183], v[242:243], v[240:241]
    v_pk_mul_f32 v[180:181], v[180:181], v[104:105]
    v_pk_mul_f32 v[182:183], v[182:183], v[106:107]
    v_exp_f32 v180, v180
    v_exp_f32 v181, v181
    v_exp_f32 v182, v182
    v_exp_f32 v183, v183
    v_pk_mul_f32 v[184:185], v[104:105], v[144:145]
    v_pk_mul_f32 v[186:187], v[106:107], v[146:147]
    v_pk_add_f32 v[180:181], v[180:181], v[244:245]
    v_pk_add_f32 v[182:183], v[182:183], v[244:245]
    v_rcp_f32 v180, v180
    v_rcp_f32 v181, v181
    v_rcp_f32 v182, v182
    v_rcp_f32 v183, v183
    v_pk_mul_f32 v[180:181], v[180:181], v[184:185]
    v_pk_mul_f32 v[182:183], v[182:183], v[186:187]
    v_cvt_pk_bf16_f32 v194, v180, v181
    v_cvt_pk_bf16_f32 v195, v182, v183
    s_nop 0
    v_permlane16_swap_b32 v192, v194
    v_permlane16_swap_b32 v193, v195
    buffer_store_dwordx4 v[192:195], v5, s[20:23], s47 offen offset:512 nt
    v_permlane32_swap_b32 v108, v148
    v_permlane32_swap_b32 v109, v149
    v_permlane32_swap_b32 v110, v150
    v_permlane32_swap_b32 v111, v151
    v_pk_mul_f32 v[172:173], v[108:109], v[108:109]
    v_pk_mul_f32 v[174:175], v[110:111], v[110:111]
    v_pk_fma_f32 v[172:173], v[172:173], v[242:243], v[240:241]
    v_pk_fma_f32 v[174:175], v[174:175], v[242:243], v[240:241]
    v_pk_mul_f32 v[172:173], v[172:173], v[108:109]
    v_pk_mul_f32 v[174:175], v[174:175], v[110:111]
    v_exp_f32 v172, v172
    v_exp_f32 v173, v173
    v_exp_f32 v174, v174
    v_exp_f32 v175, v175
    v_pk_mul_f32 v[176:177], v[108:109], v[148:149]
    v_pk_mul_f32 v[178:179], v[110:111], v[150:151]
    v_pk_add_f32 v[172:173], v[172:173], v[244:245]
    v_pk_add_f32 v[174:175], v[174:175], v[244:245]
    v_rcp_f32 v172, v172
    v_rcp_f32 v173, v173
    v_rcp_f32 v174, v174
    v_rcp_f32 v175, v175
    v_pk_mul_f32 v[172:173], v[172:173], v[176:177]
    v_pk_mul_f32 v[174:175], v[174:175], v[178:179]
    v_cvt_pk_bf16_f32 v188, v172, v173
    v_cvt_pk_bf16_f32 v189, v174, v175
    v_permlane32_swap_b32 v112, v152
    v_permlane32_swap_b32 v113, v153
    v_permlane32_swap_b32 v114, v154
    v_permlane32_swap_b32 v115, v155
    v_pk_mul_f32 v[180:181], v[112:113], v[112:113]
    v_pk_mul_f32 v[182:183], v[114:115], v[114:115]
    v_pk_fma_f32 v[180:181], v[180:181], v[242:243], v[240:241]
    v_pk_fma_f32 v[182:183], v[182:183], v[242:243], v[240:241]
    v_pk_mul_f32 v[180:181], v[180:181], v[112:113]
    v_pk_mul_f32 v[182:183], v[182:183], v[114:115]
    v_exp_f32 v180, v180
    v_exp_f32 v181, v181
    v_exp_f32 v182, v182
    v_exp_f32 v183, v183
    v_pk_mul_f32 v[184:185], v[112:113], v[152:153]
    v_pk_mul_f32 v[186:187], v[114:115], v[154:155]
    v_pk_add_f32 v[180:181], v[180:181], v[244:245]
    v_pk_add_f32 v[182:183], v[182:183], v[244:245]
    v_rcp_f32 v180, v180
    v_rcp_f32 v181, v181
    v_rcp_f32 v182, v182
    v_rcp_f32 v183, v183
    v_pk_mul_f32 v[180:181], v[180:181], v[184:185]
    v_pk_mul_f32 v[182:183], v[182:183], v[186:187]
    v_cvt_pk_bf16_f32 v190, v180, v181
    v_cvt_pk_bf16_f32 v191, v182, v183
    s_nop 0
    v_permlane16_swap_b32 v188, v190
    v_permlane16_swap_b32 v189, v191
    buffer_store_dwordx4 v[188:191], v5, s[20:23], s47 offen offset:1024 nt
    v_permlane32_swap_b32 v116, v156
    v_permlane32_swap_b32 v117, v157
    v_permlane32_swap_b32 v118, v158
    v_permlane32_swap_b32 v119, v159
    v_pk_mul_f32 v[172:173], v[116:117], v[116:117]
    v_pk_mul_f32 v[174:175], v[118:119], v[118:119]
    v_pk_fma_f32 v[172:173], v[172:173], v[242:243], v[240:241]
    v_pk_fma_f32 v[174:175], v[174:175], v[242:243], v[240:241]
    v_pk_mul_f32 v[172:173], v[172:173], v[116:117]
    v_pk_mul_f32 v[174:175], v[174:175], v[118:119]
    v_exp_f32 v172, v172
    v_exp_f32 v173, v173
    v_exp_f32 v174, v174
    v_exp_f32 v175, v175
    v_pk_mul_f32 v[176:177], v[116:117], v[156:157]
    v_pk_mul_f32 v[178:179], v[118:119], v[158:159]
    v_pk_add_f32 v[172:173], v[172:173], v[244:245]
    v_pk_add_f32 v[174:175], v[174:175], v[244:245]
    v_rcp_f32 v172, v172
    v_rcp_f32 v173, v173
    v_rcp_f32 v174, v174
    v_rcp_f32 v175, v175
    v_pk_mul_f32 v[172:173], v[172:173], v[176:177]
    v_pk_mul_f32 v[174:175], v[174:175], v[178:179]
    v_cvt_pk_bf16_f32 v192, v172, v173
    v_cvt_pk_bf16_f32 v193, v174, v175
    buffer_store_dwordx2 v[192:193], v1, s[20:23], s47 offen offset:1536 nt
    s_waitcnt vmcnt(14)
    v_mov_b32 v236, 0
    v_lshlrev_b32 v237, 16, v220
    v_lshlrev_b32 v238, 16, v228
    v_fmac_f32 v236, v237, v238
    v_and_b32 v237, 0xffff0000, v220
    v_and_b32 v238, 0xffff0000, v228
    v_fmac_f32 v236, v237, v238
    v_lshlrev_b32 v237, 16, v221
    v_lshlrev_b32 v238, 16, v229
    v_fmac_f32 v236, v237, v238
    v_and_b32 v237, 0xffff0000, v221
    v_and_b32 v238, 0xffff0000, v229
    v_fmac_f32 v236, v237, v238
    v_lshlrev_b32 v237, 16, v222
    v_lshlrev_b32 v238, 16, v230
    v_fmac_f32 v236, v237, v238
    v_and_b32 v237, 0xffff0000, v222
    v_and_b32 v238, 0xffff0000, v230
    v_fmac_f32 v236, v237, v238
    v_lshlrev_b32 v237, 16, v223
    v_lshlrev_b32 v238, 16, v231
    v_fmac_f32 v236, v237, v238
    v_and_b32 v237, 0xffff0000, v223
    v_and_b32 v238, 0xffff0000, v231
    v_fmac_f32 v236, v237, v238
    v_lshlrev_b32 v237, 16, v224
    v_lshlrev_b32 v238, 16, v232
    v_fmac_f32 v236, v237, v238
    v_and_b32 v237, 0xffff0000, v224
    v_and_b32 v238, 0xffff0000, v232
    v_fmac_f32 v236, v237, v238
    v_lshlrev_b32 v237, 16, v225
    v_lshlrev_b32 v238, 16, v233
    v_fmac_f32 v236, v237, v238
    v_and_b32 v237, 0xffff0000, v225
    v_and_b32 v238, 0xffff0000, v233
    v_fmac_f32 v236, v237, v238
    v_lshlrev_b32 v237, 16, v226
    v_lshlrev_b32 v238, 16, v234
    v_fmac_f32 v236, v237, v238
    v_and_b32 v237, 0xffff0000, v226
    v_and_b32 v238, 0xffff0000, v234
    v_fmac_f32 v236, v237, v238
    v_lshlrev_b32 v237, 16, v227
    v_lshlrev_b32 v238, 16, v235
    v_fmac_f32 v236, v237, v238
    v_and_b32 v237, 0xffff0000, v227
    v_and_b32 v238, 0xffff0000, v235
    v_fmac_f32 v236, v237, v238
    ds_swizzle_b32 v237, v236 offset:0x41f
    s_waitcnt lgkmcnt(0)
    v_add_f32 v236, v236, v237
    ds_swizzle_b32 v237, v236 offset:0x81f
    s_waitcnt lgkmcnt(0)
    v_add_f32 v236, v236, v237
    ds_swizzle_b32 v237, v236 offset:0x101f
    s_waitcnt lgkmcnt(0)
    v_add_f32 v236, v236, v237
    ds_swizzle_b32 v237, v236 offset:0x201f
    s_waitcnt lgkmcnt(0)
    v_add_f32 v236, v236, v237
    ds_swizzle_b32 v237, v236 offset:0x401f
    s_waitcnt lgkmcnt(0)
    v_add_f32 v236, v236, v237
    s_nop 0
    v_readlane_b32 s45, v236, 32
    s_nop 1
    v_add_f32 v236, s45, v236
    v_mul_f32 v236, 0xbfb8aa3b, v236
    v_exp_f32 v236, v236
    s_nop 0
    v_add_f32 v236, 1.0, v236
    v_rcp_f32 v236, v236
    s_lshl_b32 s57, s54, 2
    s_add_u32 s57, s57, 33554432
    v_mov_b32 v237, 0
    v_cmp_eq_u32 vcc, 0, v0
    s_nop 0
    s_and_saveexec_b64 s[58:59], vcc
    buffer_store_dword v236, v237, s[20:23], s57 offen
    s_mov_b64 exec, s[58:59]
L_k1_end:
    s_endpgm
.globl k2_kernel
.p2align 8
.type k2_kernel,@function
k2_kernel:
    s_cmp_ge_u32 s2, 512
    s_cbranch_scc1 L_k2_end
    s_cmp_lt_u32 s2, 256
    s_cbranch_scc1 L_k2_attn
    s_sub_u32 s2, s2, 256
    s_load_dwordx2 s[24:25], s[0:1], 48
    s_load_dwordx2 s[26:27], s[0:1], 16
    s_load_dwordx4 s[28:31], s[0:1], 64
    s_load_dwordx2 s[32:33], s[0:1], 80
    v_lshrrev_b32 v1, 6, v0
    v_and_b32 v0, 63, v0
    v_readfirstlane_b32 s34, v1
    s_waitcnt lgkmcnt(0)
    s_mov_b32 s20, s32
    s_mov_b32 s21, s33
    s_mov_b32 s22, 0x10000000
    s_mov_b32 s23, 0x00020000
    s_mov_b32 s12, s24
    s_mov_b32 s13, s25
    s_mov_b32 s14, 0x700000
    s_mov_b32 s15, 0x00020000
    s_and_b32 s45, s2, 7
    s_lshr_b32 s46, s2, 3
    s_lshr_b32 s47, s45, 1
    s_lshl_b32 s37, s47, 2
    s_and_b32 s47, s46, 3
    s_add_u32 s37, s37, s47
    s_and_b32 s47, s45, 1
    s_lshl_b32 s38, s47, 3
    s_lshr_b32 s47, s46, 2
    s_add_u32 s38, s38, s47
    s_cmp_ge_u32 s34, 4
    s_cbranch_scc1 L_dn_helper
    s_mov_b32 s16, s28
    s_mov_b32 s17, s29
    s_mov_b32 s18, 0x400000
    s_mov_b32 s19, 0x00020000
    s_lshr_b32 s35, s34, 1
    s_and_b32 s36, s34, 1
    v_lshlrev_b32 v3, 4, v0
    s_lshl_b32 s45, s35, 12
    v_add_u32 v3, s45, v3
    v_add_u32 v4, 49152, v3
    v_lshrrev_b32 v8, 4, v0
    v_bfe_u32 v9, v0, 2, 2
    v_lshl_add_u32 v10, v8, 3, v9
    v_lshlrev_b32 v10, 7, v10
    v_and_b32 v11, 3, v0
    v_lshl_add_u32 v10, v11, 3, v10
    v_add_u32 v10, 8192, v10
    v_bfe_u32 v9, v0, 3, 1
    v_and_b32 v8, 1, v8
    v_lshl_or_b32 v9, v8, 1, v9
    s_lshl_b32 s45, s36, 1
    s_add_u32 s45, s45, 0
    v_xor_b32 v8, s45, v9
    v_lshl_add_u32 v5, v8, 5, v10
    v_add_u32 v12, 49152, v5
    s_lshl_b32 s45, s36, 1
    s_add_u32 s45, s45, 1
    v_xor_b32 v8, s45, v9
    v_lshl_add_u32 v6, v8, 5, v10
    v_add_u32 v13, 49152, v6
    v_mov_b32 v16, 0
    v_mov_b32 v17, 0
    v_mov_b32 v18, 0
    v_mov_b32 v19, 0
    v_mov_b32 v20, 0
    v_mov_b32 v21, 0
    v_mov_b32 v22, 0
    v_mov_b32 v23, 0
    v_mov_b32 v24, 0
    v_mov_b32 v25, 0
    v_mov_b32 v26, 0
    v_mov_b32 v27, 0
    v_mov_b32 v28, 0
    v_mov_b32 v29, 0
    v_mov_b32 v30, 0
    v_mov_b32 v31, 0
    v_mov_b32 v32, 0
    v_mov_b32 v33, 0
    v_mov_b32 v34, 0
    v_mov_b32 v35, 0
    v_mov_b32 v36, 0
    v_mov_b32 v37, 0
    v_mov_b32 v38, 0
    v_mov_b32 v39, 0
    v_mov_b32 v40, 0
    v_mov_b32 v41, 0
    v_mov_b32 v42, 0
    v_mov_b32 v43, 0
    v_mov_b32 v44, 0
    v_mov_b32 v45, 0
    v_mov_b32 v46, 0
    v_mov_b32 v47, 0
    v_mov_b32 v48, 0
    v_mov_b32 v49, 0
    v_mov_b32 v50, 0
    v_mov_b32 v51, 0
    v_mov_b32 v52, 0
    v_mov_b32 v53, 0
    v_mov_b32 v54, 0
    v_mov_b32 v55, 0
    v_mov_b32 v56, 0
    v_mov_b32 v57, 0
    v_mov_b32 v58, 0
    v_mov_b32 v59, 0
    v_mov_b32 v60, 0
    v_mov_b32 v61, 0
    v_mov_b32 v62, 0
    v_mov_b32 v63, 0
    v_mov_b32 v64, 0
    v_mov_b32 v65, 0
    v_mov_b32 v66, 0
    v_mov_b32 v67, 0
    v_mov_b32 v68, 0
    v_mov_b32 v69, 0
    v_mov_b32 v70, 0
    v_mov_b32 v71, 0
    v_mov_b32 v72, 0
    v_mov_b32 v73, 0
    v_mov_b32 v74, 0
    v_mov_b32 v75, 0
    v_mov_b32 v76, 0
    v_mov_b32 v77, 0
    v_mov_b32 v78, 0
    v_mov_b32 v79, 0
    s_mul_i32 s45, s34, 12
    v_add_u32 v7, s45, v0
    v_lshlrev_b32 v14, 7, v7
    v_lshrrev_b32 v8, 3, v7
    v_lshlrev_b32 v15, 16, v8
    v_and_b32 v8, 7, v7
    v_lshl_add_u32 v15, v8, 11, v15
    s_lshl_b32 s45, s37, 3
    s_and_b32 s46, s38, 7
    s_add_u32 s45, s45, s46
    s_mul_i32 s45, s45, 147456
    s_add_u32 s39, s45, 12582912
    s_add_u32 s49, s39, 114688
    s_and_b32 s46, s37, 3
    s_lshl_b32 s46, s46, 14
    s_lshl_b32 s47, s38, 7
    s_add_u32 s40, s46, s47
    s_mov_b32 s48, s40
    s_add_u32 s39, s39, 6144
    s_add_u32 s40, s40, 393216
    s_barrier
    ds_read_b128 v[80:83], v3 offset:0
    ds_read_b64_tr_b16 v[112:113], v5 offset:0
    ds_read_b64_tr_b16 v[114:115], v5 offset:512
    ds_read_b128 v[84:87], v3 offset:1024
    ds_read_b64_tr_b16 v[116:117], v6 offset:0
    ds_read_b64_tr_b16 v[118:119], v6 offset:512
    ds_read_b128 v[88:91], v3 offset:2048
    ds_read_b128 v[92:95], v3 offset:3072
    s_mov_b64 exec, 0xfff
    buffer_load_dword v2, v14, s[20:23], s39 offen
    buffer_load_dword v2, v15, s[12:15], s40 offen
    s_mov_b64 exec, -1
    s_add_u32 s39, s39, 6144
    s_add_u32 s40, s40, 393216
    s_mov_b64 exec, 0xfff
    buffer_load_dword v2, v14, s[20:23], s39 offen
    buffer_load_dword v2, v15, s[12:15], s40 offen
    s_mov_b64 exec, -1
    s_add_u32 s39, s39, 6144
    s_add_u32 s40, s40, 393216
    s_mov_b64 exec, 0xfff
    buffer_load_dword v2, v14, s[20:23], s39 offen
    buffer_load_dword v2, v15, s[12:15], s40 offen
    s_mov_b64 exec, -1
    s_add_u32 s39, s39, 6144
    s_add_u32 s40, s40, 393216
    s_waitcnt lgkmcnt(0)
    s_mov_b32 s44, 18
L_dn_loop:
    s_cmp_lt_u32 s44, 5
    s_cbranch_scc1 L_dn_nopf
    s_mov_b64 exec, 0xfff
    buffer_load_dword v2, v14, s[20:23], s39 offen
    buffer_load_dword v2, v15, s[12:15], s40 offen
    s_mov_b64 exec, -1
    s_add_u32 s39, s39, 6144
    s_add_u32 s40, s40, 393216
    s_nop 3
    s_branch L_dn_pfdone
L_dn_nopf:
    s_cmp_lg_u32 s44, 4
    s_cbranch_scc1 L_dn_pfdone
    s_mov_b32 s52, s26
    s_mov_b32 s53, s27
    s_mov_b32 s54, 0x200000
    s_mov_b32 s55, 0x00020000
    v_lshrrev_b32 v7, 3, v0
    v_lshlrev_b32 v8, 16, v7
    v_and_b32 v7, 7, v0
    v_lshl_add_u32 v8, v7, 11, v8
    s_lshl_b32 s45, s34, 19
    s_add_u32 s45, s45, s48
    buffer_load_dword v2, v8, s[52:55], s45 offen
L_dn_pfdone:
    v_mfma_f32_16x16x32_bf16 v[16:19], v[112:115], v[80:83], v[16:19]
    ds_read_b128 v[96:99], v3 offset:12288
    v_mfma_f32_16x16x32_bf16 v[24:27], v[112:115], v[84:87], v[24:27]
    ds_read_b64_tr_b16 v[120:121], v5 offset:12288
    ds_read_b64_tr_b16 v[122:123], v5 offset:12800
    v_mfma_f32_16x16x32_bf16 v[32:35], v[112:115], v[88:91], v[32:35]
    ds_read_b128 v[100:103], v3 offset:13312
    v_mfma_f32_16x16x32_bf16 v[40:43], v[112:115], v[92:95], v[40:43]
    ds_read_b64_tr_b16 v[124:125], v6 offset:12288
    ds_read_b64_tr_b16 v[126:127], v6 offset:12800
    v_mfma_f32_16x16x32_bf16 v[20:23], v[116:119], v[80:83], v[20:23]
    ds_read_b128 v[104:107], v3 offset:14336
    v_mfma_f32_16x16x32_bf16 v[28:31], v[116:119], v[84:87], v[28:31]
    ds_read_b128 v[108:111], v3 offset:15360
    v_mfma_f32_16x16x32_bf16 v[36:39], v[116:119], v[88:91], v[36:39]
    v_mfma_f32_16x16x32_bf16 v[44:47], v[116:119], v[92:95], v[44:47]
    s_waitcnt lgkmcnt(0)
    s_barrier
    v_mfma_f32_16x16x32_bf16 v[16:19], v[120:123], v[96:99], v[16:19]
    ds_read_b128 v[80:83], v3 offset:24576
    v_mfma_f32_16x16x32_bf16 v[24:27], v[120:123], v[100:103], v[24:27]
    ds_read_b64_tr_b16 v[112:113], v5 offset:24576
    ds_read_b64_tr_b16 v[114:115], v5 offset:25088
    v_mfma_f32_16x16x32_bf16 v[32:35], v[120:123], v[104:107], v[32:35]
    ds_read_b128 v[84:87], v3 offset:25600
    v_mfma_f32_16x16x32_bf16 v[40:43], v[120:123], v[108:111], v[40:43]
    ds_read_b64_tr_b16 v[116:117], v6 offset:24576
    ds_read_b64_tr_b16 v[118:119], v6 offset:25088
    v_mfma_f32_16x16x32_bf16 v[20:23], v[124:127], v[96:99], v[20:23]
    ds_read_b128 v[88:91], v3 offset:26624
    v_mfma_f32_16x16x32_bf16 v[28:31], v[124:127], v[100:103], v[28:31]
    ds_read_b128 v[92:95], v3 offset:27648
    v_mfma_f32_16x16x32_bf16 v[36:39], v[124:127], v[104:107], v[36:39]
    v_mfma_f32_16x16x32_bf16 v[44:47], v[124:127], v[108:111], v[44:47]
    s_waitcnt lgkmcnt(0)
    v_mfma_f32_16x16x32_bf16 v[16:19], v[112:115], v[80:83], v[16:19]
    ds_read_b128 v[96:99], v3 offset:36864
    v_mfma_f32_16x16x32_bf16 v[24:27], v[112:115], v[84:87], v[24:27]
    ds_read_b64_tr_b16 v[120:121], v5 offset:36864
    ds_read_b64_tr_b16 v[122:123], v5 offset:37376
    v_mfma_f32_16x16x32_bf16 v[32:35], v[112:115], v[88:91], v[32:35]
    ds_read_b128 v[100:103], v3 offset:37888
    v_mfma_f32_16x16x32_bf16 v[40:43], v[112:115], v[92:95], v[40:43]
    ds_read_b64_tr_b16 v[124:125], v6 offset:36864
    ds_read_b64_tr_b16 v[126:127], v6 offset:37376
    v_mfma_f32_16x16x32_bf16 v[20:23], v[116:119], v[80:83], v[20:23]
    ds_read_b128 v[104:107], v3 offset:38912
    v_mfma_f32_16x16x32_bf16 v[28:31], v[116:119], v[84:87], v[28:31]
    ds_read_b128 v[108:111], v3 offset:39936
    v_mfma_f32_16x16x32_bf16 v[36:39], v[116:119], v[88:91], v[36:39]
    v_mfma_f32_16x16x32_bf16 v[44:47], v[116:119], v[92:95], v[44:47]
    s_waitcnt lgkmcnt(0)
    s_barrier
    v_mfma_f32_16x16x32_bf16 v[16:19], v[120:123], v[96:99], v[16:19]
    ds_read_b128 v[80:83], v4 offset:0
    v_mfma_f32_16x16x32_bf16 v[24:27], v[120:123], v[100:103], v[24:27]
    ds_read_b64_tr_b16 v[112:113], v12 offset:0
    ds_read_b64_tr_b16 v[114:115], v12 offset:512
    v_mfma_f32_16x16x32_bf16 v[32:35], v[120:123], v[104:107], v[32:35]
    ds_read_b128 v[84:87], v4 offset:1024
    v_mfma_f32_16x16x32_bf16 v[40:43], v[120:123], v[108:111], v[40:43]
    ds_read_b64_tr_b16 v[116:117], v13 offset:0
    ds_read_b64_tr_b16 v[118:119], v13 offset:512
    v_mfma_f32_16x16x32_bf16 v[20:23], v[124:127], v[96:99], v[20:23]
    ds_read_b128 v[88:91], v4 offset:2048
    v_mfma_f32_16x16x32_bf16 v[28:31], v[124:127], v[100:103], v[28:31]
    ds_read_b128 v[92:95], v4 offset:3072
    v_mfma_f32_16x16x32_bf16 v[36:39], v[124:127], v[104:107], v[36:39]
    v_mfma_f32_16x16x32_bf16 v[44:47], v[124:127], v[108:111], v[44:47]
    s_waitcnt lgkmcnt(0)
    v_mfma_f32_16x16x32_bf16 v[16:19], v[112:115], v[80:83], v[16:19]
    ds_read_b128 v[96:99], v4 offset:12288
    v_mfma_f32_16x16x32_bf16 v[24:27], v[112:115], v[84:87], v[24:27]
    ds_read_b64_tr_b16 v[120:121], v12 offset:12288
    ds_read_b64_tr_b16 v[122:123], v12 offset:12800
    v_mfma_f32_16x16x32_bf16 v[32:35], v[112:115], v[88:91], v[32:35]
    ds_read_b128 v[100:103], v4 offset:13312
    v_mfma_f32_16x16x32_bf16 v[40:43], v[112:115], v[92:95], v[40:43]
    ds_read_b64_tr_b16 v[124:125], v13 offset:12288
    ds_read_b64_tr_b16 v[126:127], v13 offset:12800
    v_mfma_f32_16x16x32_bf16 v[20:23], v[116:119], v[80:83], v[20:23]
    ds_read_b128 v[104:107], v4 offset:14336
    v_mfma_f32_16x16x32_bf16 v[28:31], v[116:119], v[84:87], v[28:31]
    ds_read_b128 v[108:111], v4 offset:15360
    v_mfma_f32_16x16x32_bf16 v[36:39], v[116:119], v[88:91], v[36:39]
    v_mfma_f32_16x16x32_bf16 v[44:47], v[116:119], v[92:95], v[44:47]
    s_waitcnt lgkmcnt(0)
    s_barrier
    v_mfma_f32_16x16x32_bf16 v[16:19], v[120:123], v[96:99], v[16:19]
    ds_read_b128 v[80:83], v3 offset:0
    v_mfma_f32_16x16x32_bf16 v[24:27], v[120:123], v[100:103], v[24:27]
    ds_read_b64_tr_b16 v[112:113], v5 offset:0
    ds_read_b64_tr_b16 v[114:115], v5 offset:512
    v_mfma_f32_16x16x32_bf16 v[32:35], v[120:123], v[104:107], v[32:35]
    ds_read_b128 v[84:87], v3 offset:1024
    v_mfma_f32_16x16x32_bf16 v[40:43], v[120:123], v[108:111], v[40:43]
    ds_read_b64_tr_b16 v[116:117], v6 offset:0
    ds_read_b64_tr_b16 v[118:119], v6 offset:512
    v_mfma_f32_16x16x32_bf16 v[20:23], v[124:127], v[96:99], v[20:23]
    ds_read_b128 v[88:91], v3 offset:2048
    v_mfma_f32_16x16x32_bf16 v[28:31], v[124:127], v[100:103], v[28:31]
    ds_read_b128 v[92:95], v3 offset:3072
    v_mfma_f32_16x16x32_bf16 v[36:39], v[124:127], v[104:107], v[36:39]
    v_mfma_f32_16x16x32_bf16 v[44:47], v[124:127], v[108:111], v[44:47]
    s_waitcnt lgkmcnt(0)
    s_sub_u32 s44, s44, 1
    s_cmp_lg_u32 s44, 0
    s_cbranch_scc1 L_dn_loop
    v_lshlrev_b32 v7, 7, v0
    s_lshl_b32 s45, s34, 13
    s_add_u32 s49, s49, s45
    buffer_load_dword v2, v7, s[20:23], s49 offen sc1
    v_and_b32 v7, 15, v0
    v_lshlrev_b32 v7, 2, v7
    s_lshl_b32 s45, s37, 9
    s_lshl_b32 s46, s35, 8
    s_add_u32 s45, s45, s46
    s_add_u32 s45, s45, 33554432
    buffer_load_dword v8, v7, s[20:23], s45 offen offset:0
    buffer_load_dword v9, v7, s[20:23], s45 offen offset:64
    buffer_load_dword v10, v7, s[20:23], s45 offen offset:128
    buffer_load_dword v11, v7, s[20:23], s45 offen offset:192
    v_mfma_f32_16x16x32_bf16 v[16:19], v[112:115], v[80:83], v[16:19]
    ds_read_b128 v[96:99], v3 offset:12288
    v_mfma_f32_16x16x32_bf16 v[24:27], v[112:115], v[84:87], v[24:27]
    ds_read_b64_tr_b16 v[120:121], v5 offset:12288
    ds_read_b64_tr_b16 v[122:123], v5 offset:12800
    v_mfma_f32_16x16x32_bf16 v[32:35], v[112:115], v[88:91], v[32:35]
    ds_read_b128 v[100:103], v3 offset:13312
    v_mfma_f32_16x16x32_bf16 v[40:43], v[112:115], v[92:95], v[40:43]
    ds_read_b64_tr_b16 v[124:125], v6 offset:12288
    ds_read_b64_tr_b16 v[126:127], v6 offset:12800
    v_mfma_f32_16x16x32_bf16 v[20:23], v[116:119], v[80:83], v[20:23]
    ds_read_b128 v[104:107], v3 offset:14336
    v_mfma_f32_16x16x32_bf16 v[28:31], v[116:119], v[84:87], v[28:31]
    ds_read_b128 v[108:111], v3 offset:15360
    v_mfma_f32_16x16x32_bf16 v[36:39], v[116:119], v[88:91], v[36:39]
    v_mfma_f32_16x16x32_bf16 v[44:47], v[116:119], v[92:95], v[44:47]
    s_waitcnt lgkmcnt(0)
    s_barrier
    v_mfma_f32_16x16x32_bf16 v[16:19], v[120:123], v[96:99], v[16:19]
    ds_read_b128 v[80:83], v3 offset:24576
    v_mfma_f32_16x16x32_bf16 v[24:27], v[120:123], v[100:103], v[24:27]
    ds_read_b64_tr_b16 v[112:113], v5 offset:24576
    ds_read_b64_tr_b16 v[114:115], v5 offset:25088
    v_mfma_f32_16x16x32_bf16 v[32:35], v[120:123], v[104:107], v[32:35]
    ds_read_b128 v[84:87], v3 offset:25600
    v_mfma_f32_16x16x32_bf16 v[40:43], v[120:123], v[108:111], v[40:43]
    ds_read_b64_tr_b16 v[116:117], v6 offset:24576
    ds_read_b64_tr_b16 v[118:119], v6 offset:25088
    v_mfma_f32_16x16x32_bf16 v[20:23], v[124:127], v[96:99], v[20:23]
    ds_read_b128 v[88:91], v3 offset:26624
    v_mfma_f32_16x16x32_bf16 v[28:31], v[124:127], v[100:103], v[28:31]
    ds_read_b128 v[92:95], v3 offset:27648
    v_mfma_f32_16x16x32_bf16 v[36:39], v[124:127], v[104:107], v[36:39]
    v_mfma_f32_16x16x32_bf16 v[44:47], v[124:127], v[108:111], v[44:47]
    s_waitcnt lgkmcnt(0)
    v_mfma_f32_16x16x32_bf16 v[16:19], v[112:115], v[80:83], v[16:19]
    ds_read_b128 v[96:99], v3 offset:36864
    v_mfma_f32_16x16x32_bf16 v[24:27], v[112:115], v[84:87], v[24:27]
    ds_read_b64_tr_b16 v[120:121], v5 offset:36864
    ds_read_b64_tr_b16 v[122:123], v5 offset:37376
    v_mfma_f32_16x16x32_bf16 v[32:35], v[112:115], v[88:91], v[32:35]
    ds_read_b128 v[100:103], v3 offset:37888
    v_mfma_f32_16x16x32_bf16 v[40:43], v[112:115], v[92:95], v[40:43]
    ds_read_b64_tr_b16 v[124:125], v6 offset:36864
    ds_read_b64_tr_b16 v[126:127], v6 offset:37376
    v_mfma_f32_16x16x32_bf16 v[20:23], v[116:119], v[80:83], v[20:23]
    ds_read_b128 v[104:107], v3 offset:38912
    v_mfma_f32_16x16x32_bf16 v[28:31], v[116:119], v[84:87], v[28:31]
    ds_read_b128 v[108:111], v3 offset:39936
    v_mfma_f32_16x16x32_bf16 v[36:39], v[116:119], v[88:91], v[36:39]
    v_mfma_f32_16x16x32_bf16 v[44:47], v[116:119], v[92:95], v[44:47]
    s_waitcnt lgkmcnt(0)
    s_barrier
    v_mfma_f32_16x16x32_bf16 v[16:19], v[120:123], v[96:99], v[16:19]
    ds_read_b128 v[80:83], v4 offset:0
    v_mfma_f32_16x16x32_bf16 v[24:27], v[120:123], v[100:103], v[24:27]
    ds_read_b64_tr_b16 v[112:113], v12 offset:0
    ds_read_b64_tr_b16 v[114:115], v12 offset:512
    v_mfma_f32_16x16x32_bf16 v[32:35], v[120:123], v[104:107], v[32:35]
    ds_read_b128 v[84:87], v4 offset:1024
    v_mfma_f32_16x16x32_bf16 v[40:43], v[120:123], v[108:111], v[40:43]
    ds_read_b64_tr_b16 v[116:117], v13 offset:0
    ds_read_b64_tr_b16 v[118:119], v13 offset:512
    v_mfma_f32_16x16x32_bf16 v[20:23], v[124:127], v[96:99], v[20:23]
    ds_read_b128 v[88:91], v4 offset:2048
    v_mfma_f32_16x16x32_bf16 v[28:31], v[124:127], v[100:103], v[28:31]
    ds_read_b128 v[92:95], v4 offset:3072
    v_mfma_f32_16x16x32_bf16 v[36:39], v[124:127], v[104:107], v[36:39]
    v_mfma_f32_16x16x32_bf16 v[44:47], v[124:127], v[108:111], v[44:47]
    s_waitcnt lgkmcnt(0)
    v_mfma_f32_16x16x32_bf16 v[48:51], v[112:115], v[80:83], v[48:51]
    ds_read_b128 v[96:99], v4 offset:12288
    v_mfma_f32_16x16x32_bf16 v[56:59], v[112:115], v[84:87], v[56:59]
    ds_read_b64_tr_b16 v[120:121], v12 offset:12288
    ds_read_b64_tr_b16 v[122:123], v12 offset:12800
    v_mfma_f32_16x16x32_bf16 v[64:67], v[112:115], v[88:91], v[64:67]
    ds_read_b128 v[100:103], v4 offset:13312
    v_mfma_f32_16x16x32_bf16 v[72:75], v[112:115], v[92:95], v[72:75]
    ds_read_b64_tr_b16 v[124:125], v13 offset:12288
    ds_read_b64_tr_b16 v[126:127], v13 offset:12800
    v_mfma_f32_16x16x32_bf16 v[52:55], v[116:119], v[80:83], v[52:55]
    ds_read_b128 v[104:107], v4 offset:14336
    v_mfma_f32_16x16x32_bf16 v[60:63], v[116:119], v[84:87], v[60:63]
    ds_read_b128 v[108:111], v4 offset:15360
    v_mfma_f32_16x16x32_bf16 v[68:71], v[116:119], v[88:91], v[68:71]
    v_mfma_f32_16x16x32_bf16 v[76:79], v[116:119], v[92:95], v[76:79]
    s_waitcnt lgkmcnt(0)
    s_barrier
    v_mfma_f32_16x16x32_bf16 v[48:51], v[120:123], v[96:99], v[48:51]
    ds_read_b128 v[80:83], v3 offset:0
    v_mfma_f32_16x16x32_bf16 v[56:59], v[120:123], v[100:103], v[56:59]
    ds_read_b64_tr_b16 v[112:113], v5 offset:0
    ds_read_b64_tr_b16 v[114:115], v5 offset:512
    v_mfma_f32_16x16x32_bf16 v[64:67], v[120:123], v[104:107], v[64:67]
    ds_read_b128 v[84:87], v3 offset:1024
    v_mfma_f32_16x16x32_bf16 v[72:75], v[120:123], v[108:111], v[72:75]
    ds_read_b64_tr_b16 v[116:117], v6 offset:0
    ds_read_b64_tr_b16 v[118:119], v6 offset:512
    v_mfma_f32_16x16x32_bf16 v[52:55], v[124:127], v[96:99], v[52:55]
    ds_read_b128 v[88:91], v3 offset:2048
    v_mfma_f32_16x16x32_bf16 v[60:63], v[124:127], v[100:103], v[60:63]
    ds_read_b128 v[92:95], v3 offset:3072
    v_mfma_f32_16x16x32_bf16 v[68:71], v[124:127], v[104:107], v[68:71]
    v_mfma_f32_16x16x32_bf16 v[76:79], v[124:127], v[108:111], v[76:79]
    s_waitcnt lgkmcnt(0)
    s_mov_b32 s44, 4
L_wo_loop:
    v_mfma_f32_16x16x32_bf16 v[48:51], v[112:115], v[80:83], v[48:51]
    ds_read_b128 v[96:99], v3 offset:12288
    v_mfma_f32_16x16x32_bf16 v[56:59], v[112:115], v[84:87], v[56:59]
    ds_read_b64_tr_b16 v[120:121], v5 offset:12288
    ds_read_b64_tr_b16 v[122:123], v5 offset:12800
    v_mfma_f32_16x16x32_bf16 v[64:67], v[112:115], v[88:91], v[64:67]
    ds_read_b128 v[100:103], v3 offset:13312
    v_mfma_f32_16x16x32_bf16 v[72:75], v[112:115], v[92:95], v[72:75]
    ds_read_b64_tr_b16 v[124:125], v6 offset:12288
    ds_read_b64_tr_b16 v[126:127], v6 offset:12800
    v_mfma_f32_16x16x32_bf16 v[52:55], v[116:119], v[80:83], v[52:55]
    ds_read_b128 v[104:107], v3 offset:14336
    v_mfma_f32_16x16x32_bf16 v[60:63], v[116:119], v[84:87], v[60:63]
    ds_read_b128 v[108:111], v3 offset:15360
    v_mfma_f32_16x16x32_bf16 v[68:71], v[116:119], v[88:91], v[68:71]
    v_mfma_f32_16x16x32_bf16 v[76:79], v[116:119], v[92:95], v[76:79]
    s_waitcnt lgkmcnt(0)
    s_barrier
    v_mfma_f32_16x16x32_bf16 v[48:51], v[120:123], v[96:99], v[48:51]
    ds_read_b128 v[80:83], v3 offset:24576
    v_mfma_f32_16x16x32_bf16 v[56:59], v[120:123], v[100:103], v[56:59]
    ds_read_b64_tr_b16 v[112:113], v5 offset:24576
    ds_read_b64_tr_b16 v[114:115], v5 offset:25088
    v_mfma_f32_16x16x32_bf16 v[64:67], v[120:123], v[104:107], v[64:67]
    ds_read_b128 v[84:87], v3 offset:25600
    v_mfma_f32_16x16x32_bf16 v[72:75], v[120:123], v[108:111], v[72:75]
    ds_read_b64_tr_b16 v[116:117], v6 offset:24576
    ds_read_b64_tr_b16 v[118:119], v6 offset:25088
    v_mfma_f32_16x16x32_bf16 v[52:55], v[124:127], v[96:99], v[52:55]
    ds_read_b128 v[88:91], v3 offset:26624
    v_mfma_f32_16x16x32_bf16 v[60:63], v[124:127], v[100:103], v[60:63]
    ds_read_b128 v[92:95], v3 offset:27648
    v_mfma_f32_16x16x32_bf16 v[68:71], v[124:127], v[104:107], v[68:71]
    v_mfma_f32_16x16x32_bf16 v[76:79], v[124:127], v[108:111], v[76:79]
    s_waitcnt lgkmcnt(0)
    v_mfma_f32_16x16x32_bf16 v[48:51], v[112:115], v[80:83], v[48:51]
    ds_read_b128 v[96:99], v3 offset:36864
    v_mfma_f32_16x16x32_bf16 v[56:59], v[112:115], v[84:87], v[56:59]
    ds_read_b64_tr_b16 v[120:121], v5 offset:36864
    ds_read_b64_tr_b16 v[122:123], v5 offset:37376
    v_mfma_f32_16x16x32_bf16 v[64:67], v[112:115], v[88:91], v[64:67]
    ds_read_b128 v[100:103], v3 offset:37888
    v_mfma_f32_16x16x32_bf16 v[72:75], v[112:115], v[92:95], v[72:75]
    ds_read_b64_tr_b16 v[124:125], v6 offset:36864
    ds_read_b64_tr_b16 v[126:127], v6 offset:37376
    v_mfma_f32_16x16x32_bf16 v[52:55], v[116:119], v[80:83], v[52:55]
    ds_read_b128 v[104:107], v3 offset:38912
    v_mfma_f32_16x16x32_bf16 v[60:63], v[116:119], v[84:87], v[60:63]
    ds_read_b128 v[108:111], v3 offset:39936
    v_mfma_f32_16x16x32_bf16 v[68:71], v[116:119], v[88:91], v[68:71]
    v_mfma_f32_16x16x32_bf16 v[76:79], v[116:119], v[92:95], v[76:79]
    s_waitcnt lgkmcnt(0)
    s_barrier
    v_mfma_f32_16x16x32_bf16 v[48:51], v[120:123], v[96:99], v[48:51]
    ds_read_b128 v[80:83], v4 offset:0
    v_mfma_f32_16x16x32_bf16 v[56:59], v[120:123], v[100:103], v[56:59]
    ds_read_b64_tr_b16 v[112:113], v12 offset:0
    ds_read_b64_tr_b16 v[114:115], v12 offset:512
    v_mfma_f32_16x16x32_bf16 v[64:67], v[120:123], v[104:107], v[64:67]
    ds_read_b128 v[84:87], v4 offset:1024
    v_mfma_f32_16x16x32_bf16 v[72:75], v[120:123], v[108:111], v[72:75]
    ds_read_b64_tr_b16 v[116:117], v13 offset:0
    ds_read_b64_tr_b16 v[118:119], v13 offset:512
    v_mfma_f32_16x16x32_bf16 v[52:55], v[124:127], v[96:99], v[52:55]
    ds_read_b128 v[88:91], v4 offset:2048
    v_mfma_f32_16x16x32_bf16 v[60:63], v[124:127], v[100:103], v[60:63]
    ds_read_b128 v[92:95], v4 offset:3072
    v_mfma_f32_16x16x32_bf16 v[68:71], v[124:127], v[104:107], v[68:71]
    v_mfma_f32_16x16x32_bf16 v[76:79], v[124:127], v[108:111], v[76:79]
    s_waitcnt lgkmcnt(0)
    v_mfma_f32_16x16x32_bf16 v[48:51], v[112:115], v[80:83], v[48:51]
    ds_read_b128 v[96:99], v4 offset:12288
    v_mfma_f32_16x16x32_bf16 v[56:59], v[112:115], v[84:87], v[56:59]
    ds_read_b64_tr_b16 v[120:121], v12 offset:12288
    ds_read_b64_tr_b16 v[122:123], v12 offset:12800
    v_mfma_f32_16x16x32_bf16 v[64:67], v[112:115], v[88:91], v[64:67]
    ds_read_b128 v[100:103], v4 offset:13312
    v_mfma_f32_16x16x32_bf16 v[72:75], v[112:115], v[92:95], v[72:75]
    ds_read_b64_tr_b16 v[124:125], v13 offset:12288
    ds_read_b64_tr_b16 v[126:127], v13 offset:12800
    v_mfma_f32_16x16x32_bf16 v[52:55], v[116:119], v[80:83], v[52:55]
    ds_read_b128 v[104:107], v4 offset:14336
    v_mfma_f32_16x16x32_bf16 v[60:63], v[116:119], v[84:87], v[60:63]
    ds_read_b128 v[108:111], v4 offset:15360
    v_mfma_f32_16x16x32_bf16 v[68:71], v[116:119], v[88:91], v[68:71]
    v_mfma_f32_16x16x32_bf16 v[76:79], v[116:119], v[92:95], v[76:79]
    s_waitcnt lgkmcnt(0)
    s_barrier
    v_mfma_f32_16x16x32_bf16 v[48:51], v[120:123], v[96:99], v[48:51]
    ds_read_b128 v[80:83], v3 offset:0
    v_mfma_f32_16x16x32_bf16 v[56:59], v[120:123], v[100:103], v[56:59]
    ds_read_b64_tr_b16 v[112:113], v5 offset:0
    ds_read_b64_tr_b16 v[114:115], v5 offset:512
    v_mfma_f32_16x16x32_bf16 v[64:67], v[120:123], v[104:107], v[64:67]
    ds_read_b128 v[84:87], v3 offset:1024
    v_mfma_f32_16x16x32_bf16 v[72:75], v[120:123], v[108:111], v[72:75]
    ds_read_b64_tr_b16 v[116:117], v6 offset:0
    ds_read_b64_tr_b16 v[118:119], v6 offset:512
    v_mfma_f32_16x16x32_bf16 v[52:55], v[124:127], v[96:99], v[52:55]
    ds_read_b128 v[88:91], v3 offset:2048
    v_mfma_f32_16x16x32_bf16 v[60:63], v[124:127], v[100:103], v[60:63]
    ds_read_b128 v[92:95], v3 offset:3072
    v_mfma_f32_16x16x32_bf16 v[68:71], v[124:127], v[104:107], v[68:71]
    v_mfma_f32_16x16x32_bf16 v[76:79], v[124:127], v[108:111], v[76:79]
    s_waitcnt lgkmcnt(0)
    s_sub_u32 s44, s44, 1
    s_cmp_lg_u32 s44, 0
    s_cbranch_scc1 L_wo_loop
    v_mfma_f32_16x16x32_bf16 v[48:51], v[112:115], v[80:83], v[48:51]
    ds_read_b128 v[96:99], v3 offset:12288
    v_mfma_f32_16x16x32_bf16 v[56:59], v[112:115], v[84:87], v[56:59]
    ds_read_b64_tr_b16 v[120:121], v5 offset:12288
    ds_read_b64_tr_b16 v[122:123], v5 offset:12800
    v_mfma_f32_16x16x32_bf16 v[64:67], v[112:115], v[88:91], v[64:67]
    ds_read_b128 v[100:103], v3 offset:13312
    v_mfma_f32_16x16x32_bf16 v[72:75], v[112:115], v[92:95], v[72:75]
    ds_read_b64_tr_b16 v[124:125], v6 offset:12288
    ds_read_b64_tr_b16 v[126:127], v6 offset:12800
    v_mfma_f32_16x16x32_bf16 v[52:55], v[116:119], v[80:83], v[52:55]
    ds_read_b128 v[104:107], v3 offset:14336
    v_mfma_f32_16x16x32_bf16 v[60:63], v[116:119], v[84:87], v[60:63]
    ds_read_b128 v[108:111], v3 offset:15360
    v_mfma_f32_16x16x32_bf16 v[68:71], v[116:119], v[88:91], v[68:71]
    v_mfma_f32_16x16x32_bf16 v[76:79], v[116:119], v[92:95], v[76:79]
    s_waitcnt lgkmcnt(0)
    s_barrier
    v_mfma_f32_16x16x32_bf16 v[48:51], v[120:123], v[96:99], v[48:51]
    ds_read_b128 v[80:83], v3 offset:24576
    v_mfma_f32_16x16x32_bf16 v[56:59], v[120:123], v[100:103], v[56:59]
    ds_read_b64_tr_b16 v[112:113], v5 offset:24576
    ds_read_b64_tr_b16 v[114:115], v5 offset:25088
    v_mfma_f32_16x16x32_bf16 v[64:67], v[120:123], v[104:107], v[64:67]
    ds_read_b128 v[84:87], v3 offset:25600
    v_mfma_f32_16x16x32_bf16 v[72:75], v[120:123], v[108:111], v[72:75]
    ds_read_b64_tr_b16 v[116:117], v6 offset:24576
    ds_read_b64_tr_b16 v[118:119], v6 offset:25088
    v_mfma_f32_16x16x32_bf16 v[52:55], v[124:127], v[96:99], v[52:55]
    ds_read_b128 v[88:91], v3 offset:26624
    v_mfma_f32_16x16x32_bf16 v[60:63], v[124:127], v[100:103], v[60:63]
    ds_read_b128 v[92:95], v3 offset:27648
    v_mfma_f32_16x16x32_bf16 v[68:71], v[124:127], v[104:107], v[68:71]
    v_mfma_f32_16x16x32_bf16 v[76:79], v[124:127], v[108:111], v[76:79]
    s_waitcnt lgkmcnt(0)
    v_mfma_f32_16x16x32_bf16 v[48:51], v[112:115], v[80:83], v[48:51]
    ds_read_b128 v[96:99], v3 offset:36864
    v_mfma_f32_16x16x32_bf16 v[56:59], v[112:115], v[84:87], v[56:59]
    ds_read_b64_tr_b16 v[120:121], v5 offset:36864
    ds_read_b64_tr_b16 v[122:123], v5 offset:37376
    v_mfma_f32_16x16x32_bf16 v[64:67], v[112:115], v[88:91], v[64:67]
    ds_read_b128 v[100:103], v3 offset:37888
    v_mfma_f32_16x16x32_bf16 v[72:75], v[112:115], v[92:95], v[72:75]
    ds_read_b64_tr_b16 v[124:125], v6 offset:36864
    ds_read_b64_tr_b16 v[126:127], v6 offset:37376
    v_mfma_f32_16x16x32_bf16 v[52:55], v[116:119], v[80:83], v[52:55]
    ds_read_b128 v[104:107], v3 offset:38912
    v_mfma_f32_16x16x32_bf16 v[60:63], v[116:119], v[84:87], v[60:63]
    ds_read_b128 v[108:111], v3 offset:39936
    v_mfma_f32_16x16x32_bf16 v[68:71], v[116:119], v[88:91], v[68:71]
    v_mfma_f32_16x16x32_bf16 v[76:79], v[116:119], v[92:95], v[76:79]
    s_waitcnt lgkmcnt(0)
    s_barrier
    v_mfma_f32_16x16x32_bf16 v[48:51], v[120:123], v[96:99], v[48:51]
    ds_read_b128 v[80:83], v4 offset:0
    v_mfma_f32_16x16x32_bf16 v[56:59], v[120:123], v[100:103], v[56:59]
    ds_read_b64_tr_b16 v[112:113], v12 offset:0
    ds_read_b64_tr_b16 v[114:115], v12 offset:512
    v_mfma_f32_16x16x32_bf16 v[64:67], v[120:123], v[104:107], v[64:67]
    ds_read_b128 v[84:87], v4 offset:1024
    v_mfma_f32_16x16x32_bf16 v[72:75], v[120:123], v[108:111], v[72:75]
    ds_read_b64_tr_b16 v[116:117], v13 offset:0
    ds_read_b64_tr_b16 v[118:119], v13 offset:512
    v_mfma_f32_16x16x32_bf16 v[52:55], v[124:127], v[96:99], v[52:55]
    ds_read_b128 v[88:91], v4 offset:2048
    v_mfma_f32_16x16x32_bf16 v[60:63], v[124:127], v[100:103], v[60:63]
    ds_read_b128 v[92:95], v4 offset:3072
    v_mfma_f32_16x16x32_bf16 v[68:71], v[124:127], v[104:107], v[68:71]
    v_mfma_f32_16x16x32_bf16 v[76:79], v[124:127], v[108:111], v[76:79]
    s_waitcnt lgkmcnt(0)
    v_mfma_f32_16x16x32_bf16 v[48:51], v[112:115], v[80:83], v[48:51]
    ds_read_b128 v[96:99], v4 offset:12288
    v_mfma_f32_16x16x32_bf16 v[56:59], v[112:115], v[84:87], v[56:59]
    ds_read_b64_tr_b16 v[120:121], v12 offset:12288
    ds_read_b64_tr_b16 v[122:123], v12 offset:12800
    v_mfma_f32_16x16x32_bf16 v[64:67], v[112:115], v[88:91], v[64:67]
    ds_read_b128 v[100:103], v4 offset:13312
    v_mfma_f32_16x16x32_bf16 v[72:75], v[112:115], v[92:95], v[72:75]
    ds_read_b64_tr_b16 v[124:125], v13 offset:12288
    ds_read_b64_tr_b16 v[126:127], v13 offset:12800
    v_mfma_f32_16x16x32_bf16 v[52:55], v[116:119], v[80:83], v[52:55]
    ds_read_b128 v[104:107], v4 offset:14336
    v_mfma_f32_16x16x32_bf16 v[60:63], v[116:119], v[84:87], v[60:63]
    ds_read_b128 v[108:111], v4 offset:15360
    v_mfma_f32_16x16x32_bf16 v[68:71], v[116:119], v[88:91], v[68:71]
    v_mfma_f32_16x16x32_bf16 v[76:79], v[116:119], v[92:95], v[76:79]
    s_waitcnt lgkmcnt(0)
    v_mfma_f32_16x16x32_bf16 v[48:51], v[120:123], v[96:99], v[48:51]
    v_mfma_f32_16x16x32_bf16 v[56:59], v[120:123], v[100:103], v[56:59]
    v_mfma_f32_16x16x32_bf16 v[64:67], v[120:123], v[104:107], v[64:67]
    v_mfma_f32_16x16x32_bf16 v[72:75], v[120:123], v[108:111], v[72:75]
    v_mfma_f32_16x16x32_bf16 v[52:55], v[124:127], v[96:99], v[52:55]
    v_mfma_f32_16x16x32_bf16 v[60:63], v[124:127], v[100:103], v[60:63]
    v_mfma_f32_16x16x32_bf16 v[68:71], v[124:127], v[104:107], v[68:71]
    v_mfma_f32_16x16x32_bf16 v[76:79], v[124:127], v[108:111], v[76:79]
    v_and_b32 v7, 15, v0
    v_lshlrev_b32 v1, 11, v7
    v_bfe_u32 v7, v0, 4, 1
    v_lshl_add_u32 v1, v7, 5, v1
    v_lshrrev_b32 v7, 5, v0
    v_lshl_add_u32 v1, v7, 4, v1
    s_lshl_b32 s45, s37, 7
    s_lshl_b32 s46, s35, 6
    s_add_u32 s45, s45, s46
    s_lshl_b32 s45, s45, 11
    s_lshl_b32 s46, s38, 7
    s_add_u32 s45, s45, s46
    s_lshl_b32 s46, s36, 6
    s_add_u32 s45, s45, s46
    s_waitcnt vmcnt(0)
    v_sub_f32 v48, v48, v16
    v_sub_f32 v49, v49, v17
    v_sub_f32 v50, v50, v18
    v_sub_f32 v51, v51, v19
    v_fmac_f32 v16, v48, v8
    v_fmac_f32 v17, v49, v8
    v_fmac_f32 v18, v50, v8
    v_fmac_f32 v19, v51, v8
    v_cvt_pk_bf16_f32 v80, v16, v17
    v_cvt_pk_bf16_f32 v81, v18, v19
    v_sub_f32 v52, v52, v20
    v_sub_f32 v53, v53, v21
    v_sub_f32 v54, v54, v22
    v_sub_f32 v55, v55, v23
    v_fmac_f32 v20, v52, v8
    v_fmac_f32 v21, v53, v8
    v_fmac_f32 v22, v54, v8
    v_fmac_f32 v23, v55, v8
    v_cvt_pk_bf16_f32 v82, v20, v21
    v_cvt_pk_bf16_f32 v83, v22, v23
    s_nop 0
    v_permlane16_swap_b32 v80, v82
    v_permlane16_swap_b32 v81, v83
    s_add_u32 s46, s45, 0
    buffer_store_dwordx4 v[80:83], v1, s[16:19], s46 offen
    v_sub_f32 v56, v56, v24
    v_sub_f32 v57, v57, v25
    v_sub_f32 v58, v58, v26
    v_sub_f32 v59, v59, v27
    v_fmac_f32 v24, v56, v9
    v_fmac_f32 v25, v57, v9
    v_fmac_f32 v26, v58, v9
    v_fmac_f32 v27, v59, v9
    v_cvt_pk_bf16_f32 v84, v24, v25
    v_cvt_pk_bf16_f32 v85, v26, v27
    v_sub_f32 v60, v60, v28
    v_sub_f32 v61, v61, v29
    v_sub_f32 v62, v62, v30
    v_sub_f32 v63, v63, v31
    v_fmac_f32 v28, v60, v9
    v_fmac_f32 v29, v61, v9
    v_fmac_f32 v30, v62, v9
    v_fmac_f32 v31, v63, v9
    v_cvt_pk_bf16_f32 v86, v28, v29
    v_cvt_pk_bf16_f32 v87, v30, v31
    s_nop 0
    v_permlane16_swap_b32 v84, v86
    v_permlane16_swap_b32 v85, v87
    s_add_u32 s46, s45, 32768
    buffer_store_dwordx4 v[84:87], v1, s[16:19], s46 offen
    v_sub_f32 v64, v64, v32
    v_sub_f32 v65, v65, v33
    v_sub_f32 v66, v66, v34
    v_sub_f32 v67, v67, v35
    v_fmac_f32 v32, v64, v10
    v_fmac_f32 v33, v65, v10
    v_fmac_f32 v34, v66, v10
    v_fmac_f32 v35, v67, v10
    v_cvt_pk_bf16_f32 v88, v32, v33
    v_cvt_pk_bf16_f32 v89, v34, v35
    v_sub_f32 v68, v68, v36
    v_sub_f32 v69, v69, v37
    v_sub_f32 v70, v70, v38
    v_sub_f32 v71, v71, v39
    v_fmac_f32 v36, v68, v10
    v_fmac_f32 v37, v69, v10
    v_fmac_f32 v38, v70, v10
    v_fmac_f32 v39, v71, v10
    v_cvt_pk_bf16_f32 v90, v36, v37
    v_cvt_pk_bf16_f32 v91, v38, v39
    s_nop 0
    v_permlane16_swap_b32 v88, v90
    v_permlane16_swap_b32 v89, v91
    s_add_u32 s46, s45, 65536
    buffer_store_dwordx4 v[88:91], v1, s[16:19], s46 offen
    v_sub_f32 v72, v72, v40
    v_sub_f32 v73, v73, v41
    v_sub_f32 v74, v74, v42
    v_sub_f32 v75, v75, v43
    v_fmac_f32 v40, v72, v11
    v_fmac_f32 v41, v73, v11
    v_fmac_f32 v42, v74, v11
    v_fmac_f32 v43, v75, v11
    v_cvt_pk_bf16_f32 v92, v40, v41
    v_cvt_pk_bf16_f32 v93, v42, v43
    v_sub_f32 v76, v76, v44
    v_sub_f32 v77, v77, v45
    v_sub_f32 v78, v78, v46
    v_sub_f32 v79, v79, v47
    v_fmac_f32 v44, v76, v11
    v_fmac_f32 v45, v77, v11
    v_fmac_f32 v46, v78, v11
    v_fmac_f32 v47, v79, v11
    v_cvt_pk_bf16_f32 v94, v44, v45
    v_cvt_pk_bf16_f32 v95, v46, v47
    s_nop 0
    v_permlane16_swap_b32 v92, v94
    v_permlane16_swap_b32 v93, v95
    s_add_u32 s46, s45, 98304
    buffer_store_dwordx4 v[92:95], v1, s[16:19], s46 offen
    s_endpgm
L_dn_helper:
    v_lshlrev_b32 v1, 4, v0
    s_sub_u32 s35, s34, 4
    s_lshl_b32 s45, s37, 3
    s_lshl_b32 s46, s35, 1
    s_add_u32 s45, s45, s46
    s_mul_i32 s45, s45, 147456
    s_add_u32 s39, s45, 12582912
    s_lshl_b32 s41, s35, 11
    s_lshl_b32 s42, s35, 10
    s_add_u32 s42, s42, 8192
    s_lshr_b32 s50, s37, 1
    s_lshl_b32 s50, s50, 8
    s_add_u32 s50, s50, 33619968
    v_lshrrev_b32 v7, 3, v0
    v_lshlrev_b32 v2, 11, v7
    v_bfe_u32 v8, v0, 4, 1
    s_and_b32 s45, s35, 1
    s_lshl_b32 s45, s45, 1
    v_or_b32 v8, s45, v8
    v_bfe_u32 v9, v0, 1, 2
    v_xor_b32 v8, v8, v9
    v_lshl_add_u32 v2, v8, 5, v2
    v_and_b32 v9, 1, v0
    v_lshl_add_u32 v2, v9, 4, v2
    s_lshl_b32 s45, s35, 14
    s_lshl_b32 s46, s38, 7
    s_add_u32 s45, s45, s46
    v_add_u32 v2, s45, v2
    s_mov_b32 s40, 0
    v_mov_b32 v4, 0
    s_add_u32 m0, s41, 0
    s_add_u32 s43, s39, 0
    buffer_load_dwordx4 v1, s[20:23], s43 offen lds
    s_add_u32 m0, s41, 1024
    s_add_u32 s43, s39, 147456
    buffer_load_dwordx4 v1, s[20:23], s43 offen lds
    s_add_u32 m0, s42, 0
    s_add_u32 s43, s40, 0
    buffer_load_dwordx4 v2, s[12:15], s43 offen lds
    s_add_u32 m0, s41, 12288
    s_add_u32 s43, s39, 1024
    buffer_load_dwordx4 v1, s[20:23], s43 offen lds
    s_add_u32 m0, s41, 13312
    s_add_u32 s43, s39, 148480
    buffer_load_dwordx4 v1, s[20:23], s43 offen lds
    s_add_u32 m0, s42, 12288
    s_add_u32 s43, s40, 65536
    buffer_load_dwordx4 v2, s[12:15], s43 offen lds
    s_add_u32 s39, s39, 2048
    s_add_u32 s40, s40, 131072
    s_add_u32 m0, s41, 24576
    s_add_u32 s43, s39, 0
    buffer_load_dwordx4 v1, s[20:23], s43 offen lds
    s_add_u32 m0, s41, 25600
    s_add_u32 s43, s39, 147456
    buffer_load_dwordx4 v1, s[20:23], s43 offen lds
    s_add_u32 m0, s42, 24576
    s_add_u32 s43, s40, 0
    buffer_load_dwordx4 v2, s[12:15], s43 offen lds
    s_add_u32 m0, s41, 36864
    s_add_u32 s43, s39, 1024
    buffer_load_dwordx4 v1, s[20:23], s43 offen lds
    s_add_u32 m0, s41, 37888
    s_add_u32 s43, s39, 148480
    buffer_load_dwordx4 v1, s[20:23], s43 offen lds
    s_add_u32 m0, s42, 36864
    s_add_u32 s43, s40, 65536
    buffer_load_dwordx4 v2, s[12:15], s43 offen lds
    s_add_u32 s39, s39, 2048
    s_add_u32 s40, s40, 131072
    s_add_u32 m0, s41, 49152
    s_add_u32 s43, s39, 0
    buffer_load_dwordx4 v1, s[20:23], s43 offen lds
    s_add_u32 m0, s41, 50176
    s_add_u32 s43, s39, 147456
    buffer_load_dwordx4 v1, s[20:23], s43 offen lds
    s_add_u32 m0, s42, 49152
    s_add_u32 s43, s40, 0
    buffer_load_dwordx4 v2, s[12:15], s43 offen lds
    s_add_u32 m0, s41, 61440
    s_add_u32 s43, s39, 1024
    buffer_load_dwordx4 v1, s[20:23], s43 offen lds
    s_add_u32 m0, s41, 62464
    s_add_u32 s43, s39, 148480
    buffer_load_dwordx4 v1, s[20:23], s43 offen lds
    s_add_u32 m0, s42, 61440
    s_add_u32 s43, s40, 65536
    buffer_load_dwordx4 v2, s[12:15], s43 offen lds
    s_add_u32 s39, s39, 2048
    s_add_u32 s40, s40, 131072
    s_waitcnt vmcnt(12)
    s_barrier
    s_mov_b32 s44, 17
L_dnl_loop:
    s_waitcnt vmcnt(6)
    s_barrier
    s_add_u32 m0, s41, 0
    s_add_u32 s43, s39, 0
    buffer_load_dwordx4 v1, s[20:23], s43 offen lds
    s_add_u32 m0, s41, 1024
    s_add_u32 s43, s39, 147456
    buffer_load_dwordx4 v1, s[20:23], s43 offen lds
    s_add_u32 m0, s42, 0
    s_add_u32 s43, s40, 0
    buffer_load_dwordx4 v2, s[12:15], s43 offen lds
    s_add_u32 m0, s41, 12288
    s_add_u32 s43, s39, 1024
    buffer_load_dwordx4 v1, s[20:23], s43 offen lds
    s_add_u32 m0, s41, 13312
    s_add_u32 s43, s39, 148480
    buffer_load_dwordx4 v1, s[20:23], s43 offen lds
    s_add_u32 m0, s42, 12288
    s_add_u32 s43, s40, 65536
    buffer_load_dwordx4 v2, s[12:15], s43 offen lds
    s_add_u32 s39, s39, 2048
    s_add_u32 s40, s40, 131072
    s_waitcnt vmcnt(6)
    s_barrier
    s_add_u32 m0, s41, 24576
    s_add_u32 s43, s39, 0
    buffer_load_dwordx4 v1, s[20:23], s43 offen lds
    s_add_u32 m0, s41, 25600
    s_add_u32 s43, s39, 147456
    buffer_load_dwordx4 v1, s[20:23], s43 offen lds
    s_add_u32 m0, s42, 24576
    s_add_u32 s43, s40, 0
    buffer_load_dwordx4 v2, s[12:15], s43 offen lds
    s_add_u32 m0, s41, 36864
    s_add_u32 s43, s39, 1024
    buffer_load_dwordx4 v1, s[20:23], s43 offen lds
    s_add_u32 m0, s41, 37888
    s_add_u32 s43, s39, 148480
    buffer_load_dwordx4 v1, s[20:23], s43 offen lds
    s_add_u32 m0, s42, 36864
    s_add_u32 s43, s40, 65536
    buffer_load_dwordx4 v2, s[12:15], s43 offen lds
    s_add_u32 s39, s39, 2048
    s_add_u32 s40, s40, 131072
    s_waitcnt vmcnt(6)
    s_barrier
    s_add_u32 m0, s41, 49152
    s_add_u32 s43, s39, 0
    buffer_load_dwordx4 v1, s[20:23], s43 offen lds
    s_add_u32 m0, s41, 50176
    s_add_u32 s43, s39, 147456
    buffer_load_dwordx4 v1, s[20:23], s43 offen lds
    s_add_u32 m0, s42, 49152
    s_add_u32 s43, s40, 0
    buffer_load_dwordx4 v2, s[12:15], s43 offen lds
    s_add_u32 m0, s41, 61440
    s_add_u32 s43, s39, 1024
    buffer_load_dwordx4 v1, s[20:23], s43 offen lds
    s_add_u32 m0, s41, 62464
    s_add_u32 s43, s39, 148480
    buffer_load_dwordx4 v1, s[20:23], s43 offen lds
    s_add_u32 m0, s42, 61440
    s_add_u32 s43, s40, 65536
    buffer_load_dwordx4 v2, s[12:15], s43 offen lds
    s_add_u32 s39, s39, 2048
    s_add_u32 s40, s40, 131072
    s_sub_u32 s44, s44, 1
    s_cmp_lg_u32 s44, 0
    s_cbranch_scc1 L_dnl_loop
    s_waitcnt vmcnt(6)
    s_barrier
    s_add_u32 m0, s41, 0
    s_add_u32 s43, s39, 0
    buffer_load_dwordx4 v1, s[20:23], s43 offen lds
    s_add_u32 m0, s41, 1024
    s_add_u32 s43, s39, 147456
    buffer_load_dwordx4 v1, s[20:23], s43 offen lds
    s_add_u32 m0, s42, 0
    s_add_u32 s43, s40, 0
    buffer_load_dwordx4 v2, s[12:15], s43 offen lds
    s_add_u32 m0, s41, 12288
    s_add_u32 s43, s39, 1024
    buffer_load_dwordx4 v1, s[20:23], s43 offen lds
    s_add_u32 m0, s41, 13312
    s_add_u32 s43, s39, 148480
    buffer_load_dwordx4 v1, s[20:23], s43 offen lds
    s_add_u32 m0, s42, 12288
    s_add_u32 s43, s40, 65536
    buffer_load_dwordx4 v2, s[12:15], s43 offen lds
    s_add_u32 s39, s39, 2048
    s_add_u32 s40, s40, 131072
    s_waitcnt vmcnt(6)
    s_barrier
    s_add_u32 m0, s41, 24576
    s_add_u32 s43, s39, 0
    buffer_load_dwordx4 v1, s[20:23], s43 offen lds
    s_add_u32 m0, s41, 25600
    s_add_u32 s43, s39, 147456
    buffer_load_dwordx4 v1, s[20:23], s43 offen lds
    s_add_u32 m0, s42, 24576
    s_add_u32 s43, s40, 0
    buffer_load_dwordx4 v2, s[12:15], s43 offen lds
    s_add_u32 m0, s41, 36864
    s_add_u32 s43, s39, 1024
    buffer_load_dwordx4 v1, s[20:23], s43 offen lds
    s_add_u32 m0, s41, 37888
    s_add_u32 s43, s39, 148480
    buffer_load_dwordx4 v1, s[20:23], s43 offen lds
    s_add_u32 m0, s42, 36864
    s_add_u32 s43, s40, 65536
    buffer_load_dwordx4 v2, s[12:15], s43 offen lds
    s_add_u32 s39, s39, 2048
    s_add_u32 s40, s40, 131072
    s_cmp_lg_u32 s34, 4
    s_cbranch_scc1 L_dn_pollok
L_dn_poll:
    buffer_load_dword v3, v4, s[20:23], s50 offen sc0 sc1
    s_waitcnt vmcnt(0)
    v_readfirstlane_b32 s51, v3
    s_nop 0
    s_cmp_ge_u32 s51, 32
    s_cbranch_scc1 L_dn_pollok
    s_sleep 4
    s_branch L_dn_poll
L_dn_pollok:
    s_waitcnt vmcnt(6)
    s_barrier
    s_mov_b32 s12, s26
    s_mov_b32 s13, s27
    s_mov_b32 s14, 2097152
    s_mov_b32 s40, 0
    s_add_u32 m0, s41, 49152
    s_add_u32 s43, s39, 0
    buffer_load_dwordx4 v1, s[20:23], s43 offen sc1 lds
    s_add_u32 m0, s41, 50176
    s_add_u32 s43, s39, 147456
    buffer_load_dwordx4 v1, s[20:23], s43 offen sc1 lds
    s_add_u32 m0, s42, 49152
    s_add_u32 s43, s40, 0
    buffer_load_dwordx4 v2, s[12:15], s43 offen lds
    s_add_u32 m0, s41, 61440
    s_add_u32 s43, s39, 1024
    buffer_load_dwordx4 v1, s[20:23], s43 offen sc1 lds
    s_add_u32 m0, s41, 62464
    s_add_u32 s43, s39, 148480
    buffer_load_dwordx4 v1, s[20:23], s43 offen sc1 lds
    s_add_u32 m0, s42, 61440
    s_add_u32 s43, s40, 65536
    buffer_load_dwordx4 v2, s[12:15], s43 offen lds
    s_add_u32 s39, s39, 2048
    s_add_u32 s40, s40, 131072
    s_waitcnt vmcnt(6)
    s_barrier
    s_add_u32 m0, s41, 0
    s_add_u32 s43, s39, 0
    buffer_load_dwordx4 v1, s[20:23], s43 offen sc1 lds
    s_add_u32 m0, s41, 1024
    s_add_u32 s43, s39, 147456
    buffer_load_dwordx4 v1, s[20:23], s43 offen sc1 lds
    s_add_u32 m0, s42, 0
    s_add_u32 s43, s40, 0
    buffer_load_dwordx4 v2, s[12:15], s43 offen lds
    s_add_u32 m0, s41, 12288
    s_add_u32 s43, s39, 1024
    buffer_load_dwordx4 v1, s[20:23], s43 offen sc1 lds
    s_add_u32 m0, s41, 13312
    s_add_u32 s43, s39, 148480
    buffer_load_dwordx4 v1, s[20:23], s43 offen sc1 lds
    s_add_u32 m0, s42, 12288
    s_add_u32 s43, s40, 65536
    buffer_load_dwordx4 v2, s[12:15], s43 offen lds
    s_add_u32 s39, s39, 2048
    s_add_u32 s40, s40, 131072
    s_waitcnt vmcnt(6)
    s_barrier
    s_add_u32 m0, s41, 24576
    s_add_u32 s43, s39, 0
    buffer_load_dwordx4 v1, s[20:23], s43 offen sc1 lds
    s_add_u32 m0, s41, 25600
    s_add_u32 s43, s39, 147456
    buffer_load_dwordx4 v1, s[20:23], s43 offen sc1 lds
    s_add_u32 m0, s42, 24576
    s_add_u32 s43, s40, 0
    buffer_load_dwordx4 v2, s[12:15], s43 offen lds
    s_add_u32 m0, s41, 36864
    s_add_u32 s43, s39, 1024
    buffer_load_dwordx4 v1, s[20:23], s43 offen sc1 lds
    s_add_u32 m0, s41, 37888
    s_add_u32 s43, s39, 148480
    buffer_load_dwordx4 v1, s[20:23], s43 offen sc1 lds
    s_add_u32 m0, s42, 36864
    s_add_u32 s43, s40, 65536
    buffer_load_dwordx4 v2, s[12:15], s43 offen lds
    s_add_u32 s39, s39, 2048
    s_add_u32 s40, s40, 131072
    s_waitcnt vmcnt(6)
    s_barrier
    s_add_u32 m0, s41, 49152
    s_add_u32 s43, s39, 0
    buffer_load_dwordx4 v1, s[20:23], s43 offen sc1 lds
    s_add_u32 m0, s41, 50176
    s_add_u32 s43, s39, 147456
    buffer_load_dwordx4 v1, s[20:23], s43 offen sc1 lds
    s_add_u32 m0, s42, 49152
    s_add_u32 s43, s40, 0
    buffer_load_dwordx4 v2, s[12:15], s43 offen lds
    s_add_u32 m0, s41, 61440
    s_add_u32 s43, s39, 1024
    buffer_load_dwordx4 v1, s[20:23], s43 offen sc1 lds
    s_add_u32 m0, s41, 62464
    s_add_u32 s43, s39, 148480
    buffer_load_dwordx4 v1, s[20:23], s43 offen sc1 lds
    s_add_u32 m0, s42, 61440
    s_add_u32 s43, s40, 65536
    buffer_load_dwordx4 v2, s[12:15], s43 offen lds
    s_add_u32 s39, s39, 2048
    s_add_u32 s40, s40, 131072
    s_mov_b32 s44, 4
L_dnl_loop2:
    s_waitcnt vmcnt(6)
    s_barrier
    s_add_u32 m0, s41, 0
    s_add_u32 s43, s39, 0
    buffer_load_dwordx4 v1, s[20:23], s43 offen sc1 lds
    s_add_u32 m0, s41, 1024
    s_add_u32 s43, s39, 147456
    buffer_load_dwordx4 v1, s[20:23], s43 offen sc1 lds
    s_add_u32 m0, s42, 0
    s_add_u32 s43, s40, 0
    buffer_load_dwordx4 v2, s[12:15], s43 offen lds
    s_add_u32 m0, s41, 12288
    s_add_u32 s43, s39, 1024
    buffer_load_dwordx4 v1, s[20:23], s43 offen sc1 lds
    s_add_u32 m0, s41, 13312
    s_add_u32 s43, s39, 148480
    buffer_load_dwordx4 v1, s[20:23], s43 offen sc1 lds
    s_add_u32 m0, s42, 12288
    s_add_u32 s43, s40, 65536
    buffer_load_dwordx4 v2, s[12:15], s43 offen lds
    s_add_u32 s39, s39, 2048
    s_add_u32 s40, s40, 131072
    s_waitcnt vmcnt(6)
    s_barrier
    s_add_u32 m0, s41, 24576
    s_add_u32 s43, s39, 0
    buffer_load_dwordx4 v1, s[20:23], s43 offen sc1 lds
    s_add_u32 m0, s41, 25600
    s_add_u32 s43, s39, 147456
    buffer_load_dwordx4 v1, s[20:23], s43 offen sc1 lds
    s_add_u32 m0, s42, 24576
    s_add_u32 s43, s40, 0
    buffer_load_dwordx4 v2, s[12:15], s43 offen lds
    s_add_u32 m0, s41, 36864
    s_add_u32 s43, s39, 1024
    buffer_load_dwordx4 v1, s[20:23], s43 offen sc1 lds
    s_add_u32 m0, s41, 37888
    s_add_u32 s43, s39, 148480
    buffer_load_dwordx4 v1, s[20:23], s43 offen sc1 lds
    s_add_u32 m0, s42, 36864
    s_add_u32 s43, s40, 65536
    buffer_load_dwordx4 v2, s[12:15], s43 offen lds
    s_add_u32 s39, s39, 2048
    s_add_u32 s40, s40, 131072
    s_waitcnt vmcnt(6)
    s_barrier
    s_add_u32 m0, s41, 49152
    s_add_u32 s43, s39, 0
    buffer_load_dwordx4 v1, s[20:23], s43 offen sc1 lds
    s_add_u32 m0, s41, 50176
    s_add_u32 s43, s39, 147456
    buffer_load_dwordx4 v1, s[20:23], s43 offen sc1 lds
    s_add_u32 m0, s42, 49152
    s_add_u32 s43, s40, 0
    buffer_load_dwordx4 v2, s[12:15], s43 offen lds
    s_add_u32 m0, s41, 61440
    s_add_u32 s43, s39, 1024
    buffer_load_dwordx4 v1, s[20:23], s43 offen sc1 lds
    s_add_u32 m0, s41, 62464
    s_add_u32 s43, s39, 148480
    buffer_load_dwordx4 v1, s[20:23], s43 offen sc1 lds
    s_add_u32 m0, s42, 61440
    s_add_u32 s43, s40, 65536
    buffer_load_dwordx4 v2, s[12:15], s43 offen lds
    s_add_u32 s39, s39, 2048
    s_add_u32 s40, s40, 131072
    s_sub_u32 s44, s44, 1
    s_cmp_lg_u32 s44, 0
    s_cbranch_scc1 L_dnl_loop2
    s_waitcnt vmcnt(6)
    s_barrier
    s_waitcnt vmcnt(0)
    s_barrier
    s_endpgm
L_k2_attn:
    s_mov_b32 s60, 0
    s_load_dwordx2 s[30:31], s[0:1], 80
    s_load_dwordx2 s[24:25], s[0:1], 48
    s_load_dwordx2 s[26:27], s[0:1], 16
    v_lshrrev_b32 v1, 6, v0
    v_and_b32 v0, 63, v0
    v_readfirstlane_b32 s34, v1
    s_waitcnt lgkmcnt(0)
    s_mov_b32 s20, s30
    s_mov_b32 s21, s31
    s_mov_b32 s22, 0x10000000
    s_mov_b32 s23, 0x00020000
    s_and_b32 s45, s2, 7
    s_lshr_b32 s46, s2, 3
    s_lshr_b32 s47, s46, 3
    s_lshl_b32 s37, s45, 2
    s_add_u32 s37, s37, s47
    s_and_b32 s38, s46, 7
    s_lshl_b32 s38, s38, 3
    s_add_u32 s38, s38, s34
    s_lshl_b32 s39, s37, 17
    v_lshlrev_b32 v1, 4, v0
    s_lshl_b32 s45, s38, 11
    s_add_u32 s45, s45, s39
    buffer_load_dwordx4 v[8:11], v1, s[20:23], s45 offen
    buffer_load_dwordx4 v[12:15], v1, s[20:23], s45 offen offset:1024
    s_lshl_b32 s46, s34, 10
    s_add_u32 s40, s39, s46
    s_add_u32 s41, s40, 8388608
    s_add_u32 s40, s40, 4194304
    s_add_u32 m0, s46, 0
    s_nop 0
    buffer_load_dwordx4 v1, s[20:23], s40 offen lds
    s_add_u32 m0, s46, 8192
    s_add_u32 s40, s40, 8192
    buffer_load_dwordx4 v1, s[20:23], s41 offen lds
    s_add_u32 s41, s41, 8192
    s_add_u32 m0, s46, 16384
    s_nop 0
    buffer_load_dwordx4 v1, s[20:23], s40 offen lds
    s_add_u32 m0, s46, 24576
    s_add_u32 s40, s40, 8192
    buffer_load_dwordx4 v1, s[20:23], s41 offen lds
    s_add_u32 s41, s41, 8192
    s_add_u32 m0, s46, 32768
    s_nop 0
    buffer_load_dwordx4 v1, s[20:23], s40 offen lds
    s_add_u32 m0, s46, 40960
    s_add_u32 s40, s40, 8192
    buffer_load_dwordx4 v1, s[20:23], s41 offen lds
    s_add_u32 s41, s41, 8192
    s_add_u32 m0, s46, 49152
    s_nop 0
    buffer_load_dwordx4 v1, s[20:23], s40 offen lds
    s_add_u32 m0, s46, 57344
    s_add_u32 s40, s40, 8192
    buffer_load_dwordx4 v1, s[20:23], s41 offen lds
    s_add_u32 s41, s41, 8192
    v_mov_b32 v16, 0
    v_mov_b32 v17, 0
    v_mov_b32 v18, 0
    v_mov_b32 v19, 0
    v_mov_b32 v20, 0
    v_mov_b32 v21, 0
    v_mov_b32 v22, 0
    v_mov_b32 v23, 0
    v_mov_b32 v24, 0
    v_mov_b32 v25, 0
    v_mov_b32 v26, 0
    v_mov_b32 v27, 0
    v_mov_b32 v28, 0
    v_mov_b32 v29, 0
    v_mov_b32 v30, 0
    v_mov_b32 v31, 0
    v_mov_b32 v72, 0
    v_mov_b32 v73, 0
    v_mov_b32 v74, 0
    v_mov_b32 v75, 0
    v_mov_b32 v76, 0
    v_mov_b32 v77, 0
    v_mov_b32 v78, 0
    v_mov_b32 v79, 0
    v_mov_b32 v80, 0
    v_mov_b32 v81, 0
    v_mov_b32 v82, 0
    v_mov_b32 v83, 0
    v_mov_b32 v84, 0
    v_mov_b32 v85, 0
    v_mov_b32 v86, 0
    v_mov_b32 v87, 0
    v_mov_b32 v124, 0
    v_mov_b32 v125, 0
    v_mov_b32 v126, 0
    v_mov_b32 v127, 0
    v_and_b32 v4, 15, v0
    v_bfe_u32 v5, v0, 4, 1
    v_mov_b32 v6, 0x3f803f80
    v_cmp_eq_u32 vcc, v4, v5
    s_nop 1
    v_cndmask_b32 v120, 0, v6, vcc
    v_cndmask_b32 v121, 0, v6, vcc
    v_cndmask_b32 v122, 0, v6, vcc
    v_cndmask_b32 v123, 0, v6, vcc
    s_waitcnt vmcnt(6)
    s_barrier
    ds_read_b128 v[88:91], v1 offset:0
    ds_read_b128 v[92:95], v1 offset:1024
    ds_read_b128 v[96:99], v1 offset:2048
    ds_read_b128 v[100:103], v1 offset:3072
    ds_read_b128 v[104:107], v1 offset:8192
    ds_read_b128 v[108:111], v1 offset:9216
    s_waitcnt lgkmcnt(0)
    v_mfma_f32_32x32x16_bf16 v[32:47], v[88:91], v[8:11], v[16:31]
    v_mfma_f32_32x32x16_bf16 v[32:47], v[92:95], v[12:15], v[32:47]
    s_nop 7
    s_nop 3
    v_max3_f32 v4, v32, v33, v34
    v_max3_f32 v5, v35, v36, v37
    v_max3_f32 v4, v4, v38, v39
    v_max3_f32 v5, v5, v40, v41
    v_max3_f32 v4, v4, v42, v43
    v_max3_f32 v5, v5, v44, v45
    v_max3_f32 v4, v4, v46, v47
    v_max_f32 v4, v4, v5
    v_mov_b32 v5, v4
    s_nop 1
    v_permlane32_swap_b32 v4, v5
    v_max_f32 v4, v4, v5
    v_sub_f32 v16, 0, v4
    v_sub_f32 v17, 0, v4
    v_sub_f32 v18, 0, v4
    v_sub_f32 v19, 0, v4
    v_sub_f32 v20, 0, v4
    v_sub_f32 v21, 0, v4
    v_sub_f32 v22, 0, v4
    v_sub_f32 v23, 0, v4
    v_sub_f32 v24, 0, v4
    v_sub_f32 v25, 0, v4
    v_sub_f32 v26, 0, v4
    v_sub_f32 v27, 0, v4
    v_sub_f32 v28, 0, v4
    v_sub_f32 v29, 0, v4
    v_sub_f32 v30, 0, v4
    v_sub_f32 v31, 0, v4
    v_sub_f32 v32, v32, v4
    v_sub_f32 v33, v33, v4
    v_sub_f32 v34, v34, v4
    v_sub_f32 v35, v35, v4
    v_sub_f32 v36, v36, v4
    v_sub_f32 v37, v37, v4
    v_sub_f32 v38, v38, v4
    v_sub_f32 v39, v39, v4
    v_sub_f32 v40, v40, v4
    v_sub_f32 v41, v41, v4
    v_sub_f32 v42, v42, v4
    v_sub_f32 v43, v43, v4
    v_sub_f32 v44, v44, v4
    v_sub_f32 v45, v45, v4
    v_sub_f32 v46, v46, v4
    v_sub_f32 v47, v47, v4
    v_mfma_f32_32x32x16_bf16 v[48:63], v[96:99], v[8:11], v[16:31]
    v_exp_f32 v32, v32
    v_exp_f32 v33, v33
    v_exp_f32 v34, v34
    v_exp_f32 v35, v35
    v_mfma_f32_32x32x16_bf16 v[48:63], v[100:103], v[12:15], v[48:63]
    v_exp_f32 v36, v36
    v_exp_f32 v37, v37
    v_exp_f32 v38, v38
    v_exp_f32 v39, v39
    ds_read_b128 v[88:91], v1 offset:4096
    ds_read_b128 v[92:95], v1 offset:5120
    v_cvt_pk_bf16_f32 v64, v32, v33
    v_cvt_pk_bf16_f32 v65, v34, v35
    v_cvt_pk_bf16_f32 v66, v36, v37
    v_cvt_pk_bf16_f32 v67, v38, v39
    v_exp_f32 v40, v40
    v_exp_f32 v41, v41
    v_mfma_f32_32x32x16_bf16 v[72:87], v[104:107], v[64:67], v[72:87]
    v_exp_f32 v42, v42
    v_exp_f32 v43, v43
    v_exp_f32 v44, v44
    v_mfma_f32_16x16x32_bf16 v[124:127], v[120:123], v[64:67], v[124:127]
    ds_read_b128 v[112:115], v1 offset:10240
    ds_read_b128 v[116:119], v1 offset:11264
    v_exp_f32 v45, v45
    v_exp_f32 v46, v46
    v_exp_f32 v47, v47
    v_cvt_pk_bf16_f32 v68, v40, v41
    v_cvt_pk_bf16_f32 v69, v42, v43
    v_cvt_pk_bf16_f32 v70, v44, v45
    v_cvt_pk_bf16_f32 v71, v46, v47
    s_nop 1
    v_mfma_f32_32x32x16_bf16 v[72:87], v[108:111], v[68:71], v[72:87]
    v_mfma_f32_16x16x32_bf16 v[124:127], v[120:123], v[68:71], v[124:127]
    s_waitcnt lgkmcnt(0)
    v_mfma_f32_32x32x16_bf16 v[32:47], v[88:91], v[8:11], v[16:31]
    v_exp_f32 v48, v48
    v_exp_f32 v49, v49
    v_exp_f32 v50, v50
    v_exp_f32 v51, v51
    v_mfma_f32_32x32x16_bf16 v[32:47], v[92:95], v[12:15], v[32:47]
    v_exp_f32 v52, v52
    v_exp_f32 v53, v53
    v_exp_f32 v54, v54
    v_exp_f32 v55, v55
    ds_read_b128 v[96:99], v1 offset:6144
    ds_read_b128 v[100:103], v1 offset:7168
    v_cvt_pk_bf16_f32 v64, v48, v49
    v_cvt_pk_bf16_f32 v65, v50, v51
    v_cvt_pk_bf16_f32 v66, v52, v53
    v_cvt_pk_bf16_f32 v67, v54, v55
    v_exp_f32 v56, v56
    v_exp_f32 v57, v57
    v_mfma_f32_32x32x16_bf16 v[72:87], v[112:115], v[64:67], v[72:87]
    v_exp_f32 v58, v58
    v_exp_f32 v59, v59
    v_exp_f32 v60, v60
    v_mfma_f32_16x16x32_bf16 v[124:127], v[120:123], v[64:67], v[124:127]
    ds_read_b128 v[104:107], v1 offset:12288
    ds_read_b128 v[108:111], v1 offset:13312
    v_exp_f32 v61, v61
    v_exp_f32 v62, v62
    v_exp_f32 v63, v63
    v_cvt_pk_bf16_f32 v68, v56, v57
    v_cvt_pk_bf16_f32 v69, v58, v59
    v_cvt_pk_bf16_f32 v70, v60, v61
    v_cvt_pk_bf16_f32 v71, v62, v63
    s_nop 1
    v_mfma_f32_32x32x16_bf16 v[72:87], v[116:119], v[68:71], v[72:87]
    v_mfma_f32_16x16x32_bf16 v[124:127], v[120:123], v[68:71], v[124:127]
    s_waitcnt lgkmcnt(0)
    s_waitcnt vmcnt(4)
    s_barrier
    v_mfma_f32_32x32x16_bf16 v[48:63], v[96:99], v[8:11], v[16:31]
    v_exp_f32 v32, v32
    v_exp_f32 v33, v33
    v_exp_f32 v34, v34
    v_exp_f32 v35, v35
    v_mfma_f32_32x32x16_bf16 v[48:63], v[100:103], v[12:15], v[48:63]
    v_exp_f32 v36, v36
    v_exp_f32 v37, v37
    v_exp_f32 v38, v38
    v_exp_f32 v39, v39
    ds_read_b128 v[88:91], v1 offset:16384
    ds_read_b128 v[92:95], v1 offset:17408
    v_cvt_pk_bf16_f32 v64, v32, v33
    v_cvt_pk_bf16_f32 v65, v34, v35
    v_cvt_pk_bf16_f32 v66, v36, v37
    v_cvt_pk_bf16_f32 v67, v38, v39
    v_exp_f32 v40, v40
    v_exp_f32 v41, v41
    v_mfma_f32_32x32x16_bf16 v[72:87], v[104:107], v[64:67], v[72:87]
    v_exp_f32 v42, v42
    v_exp_f32 v43, v43
    v_exp_f32 v44, v44
    v_mfma_f32_16x16x32_bf16 v[124:127], v[120:123], v[64:67], v[124:127]
    ds_read_b128 v[112:115], v1 offset:14336
    ds_read_b128 v[116:119], v1 offset:15360
    v_exp_f32 v45, v45
    v_exp_f32 v46, v46
    v_exp_f32 v47, v47
    v_cvt_pk_bf16_f32 v68, v40, v41
    v_cvt_pk_bf16_f32 v69, v42, v43
    v_cvt_pk_bf16_f32 v70, v44, v45
    v_cvt_pk_bf16_f32 v71, v46, v47
    s_nop 1
    v_mfma_f32_32x32x16_bf16 v[72:87], v[108:111], v[68:71], v[72:87]
    v_mfma_f32_16x16x32_bf16 v[124:127], v[120:123], v[68:71], v[124:127]
    s_waitcnt lgkmcnt(0)
    v_mfma_f32_32x32x16_bf16 v[32:47], v[88:91], v[8:11], v[16:31]
    v_exp_f32 v48, v48
    v_exp_f32 v49, v49
    v_exp_f32 v50, v50
    v_exp_f32 v51, v51
    v_mfma_f32_32x32x16_bf16 v[32:47], v[92:95], v[12:15], v[32:47]
    v_exp_f32 v52, v52
    v_exp_f32 v53, v53
    v_exp_f32 v54, v54
    v_exp_f32 v55, v55
    ds_read_b128 v[96:99], v1 offset:18432
    ds_read_b128 v[100:103], v1 offset:19456
    v_cvt_pk_bf16_f32 v64, v48, v49
    v_cvt_pk_bf16_f32 v65, v50, v51
    v_cvt_pk_bf16_f32 v66, v52, v53
    v_cvt_pk_bf16_f32 v67, v54, v55
    v_exp_f32 v56, v56
    v_exp_f32 v57, v57
    v_mfma_f32_32x32x16_bf16 v[72:87], v[112:115], v[64:67], v[72:87]
    v_exp_f32 v58, v58
    v_exp_f32 v59, v59
    v_exp_f32 v60, v60
    v_mfma_f32_16x16x32_bf16 v[124:127], v[120:123], v[64:67], v[124:127]
    ds_read_b128 v[104:107], v1 offset:24576
    ds_read_b128 v[108:111], v1 offset:25600
    v_exp_f32 v61, v61
    v_exp_f32 v62, v62
    v_exp_f32 v63, v63
    v_cvt_pk_bf16_f32 v68, v56, v57
    v_cvt_pk_bf16_f32 v69, v58, v59
    v_cvt_pk_bf16_f32 v70, v60, v61
    v_cvt_pk_bf16_f32 v71, v62, v63
    s_nop 1
    v_mfma_f32_32x32x16_bf16 v[72:87], v[116:119], v[68:71], v[72:87]
    v_mfma_f32_16x16x32_bf16 v[124:127], v[120:123], v[68:71], v[124:127]
    s_waitcnt lgkmcnt(0)
    v_mfma_f32_32x32x16_bf16 v[48:63], v[96:99], v[8:11], v[16:31]
    v_exp_f32 v32, v32
    v_exp_f32 v33, v33
    v_exp_f32 v34, v34
    v_exp_f32 v35, v35
    v_mfma_f32_32x32x16_bf16 v[48:63], v[100:103], v[12:15], v[48:63]
    v_exp_f32 v36, v36
    v_exp_f32 v37, v37
    v_exp_f32 v38, v38
    v_exp_f32 v39, v39
    ds_read_b128 v[88:91], v1 offset:20480
    ds_read_b128 v[92:95], v1 offset:21504
    v_cvt_pk_bf16_f32 v64, v32, v33
    v_cvt_pk_bf16_f32 v65, v34, v35
    v_cvt_pk_bf16_f32 v66, v36, v37
    v_cvt_pk_bf16_f32 v67, v38, v39
    v_exp_f32 v40, v40
    v_exp_f32 v41, v41
    v_mfma_f32_32x32x16_bf16 v[72:87], v[104:107], v[64:67], v[72:87]
    v_exp_f32 v42, v42
    v_exp_f32 v43, v43
    v_exp_f32 v44, v44
    v_mfma_f32_16x16x32_bf16 v[124:127], v[120:123], v[64:67], v[124:127]
    ds_read_b128 v[112:115], v1 offset:26624
    ds_read_b128 v[116:119], v1 offset:27648
    v_exp_f32 v45, v45
    v_exp_f32 v46, v46
    v_exp_f32 v47, v47
    v_cvt_pk_bf16_f32 v68, v40, v41
    v_cvt_pk_bf16_f32 v69, v42, v43
    v_cvt_pk_bf16_f32 v70, v44, v45
    v_cvt_pk_bf16_f32 v71, v46, v47
    s_nop 1
    v_mfma_f32_32x32x16_bf16 v[72:87], v[108:111], v[68:71], v[72:87]
    v_mfma_f32_16x16x32_bf16 v[124:127], v[120:123], v[68:71], v[124:127]
    s_waitcnt lgkmcnt(0)
    v_mfma_f32_32x32x16_bf16 v[32:47], v[88:91], v[8:11], v[16:31]
    v_exp_f32 v48, v48
    v_exp_f32 v49, v49
    v_exp_f32 v50, v50
    v_exp_f32 v51, v51
    v_mfma_f32_32x32x16_bf16 v[32:47], v[92:95], v[12:15], v[32:47]
    v_exp_f32 v52, v52
    v_exp_f32 v53, v53
    v_exp_f32 v54, v54
    v_exp_f32 v55, v55
    ds_read_b128 v[96:99], v1 offset:22528
    ds_read_b128 v[100:103], v1 offset:23552
    v_cvt_pk_bf16_f32 v64, v48, v49
    v_cvt_pk_bf16_f32 v65, v50, v51
    v_cvt_pk_bf16_f32 v66, v52, v53
    v_cvt_pk_bf16_f32 v67, v54, v55
    v_exp_f32 v56, v56
    v_exp_f32 v57, v57
    v_mfma_f32_32x32x16_bf16 v[72:87], v[112:115], v[64:67], v[72:87]
    v_exp_f32 v58, v58
    v_exp_f32 v59, v59
    v_exp_f32 v60, v60
    v_mfma_f32_16x16x32_bf16 v[124:127], v[120:123], v[64:67], v[124:127]
    ds_read_b128 v[104:107], v1 offset:28672
    ds_read_b128 v[108:111], v1 offset:29696
    v_exp_f32 v61, v61
    v_exp_f32 v62, v62
    v_exp_f32 v63, v63
    v_cvt_pk_bf16_f32 v68, v56, v57
    v_cvt_pk_bf16_f32 v69, v58, v59
    v_cvt_pk_bf16_f32 v70, v60, v61
    v_cvt_pk_bf16_f32 v71, v62, v63
    s_nop 1
    v_mfma_f32_32x32x16_bf16 v[72:87], v[116:119], v[68:71], v[72:87]
    v_mfma_f32_16x16x32_bf16 v[124:127], v[120:123], v[68:71], v[124:127]
    s_waitcnt lgkmcnt(0)
    s_waitcnt vmcnt(2)
    s_barrier
    v_mfma_f32_32x32x16_bf16 v[48:63], v[96:99], v[8:11], v[16:31]
    v_exp_f32 v32, v32
    v_exp_f32 v33, v33
    v_exp_f32 v34, v34
    v_exp_f32 v35, v35
    v_mfma_f32_32x32x16_bf16 v[48:63], v[100:103], v[12:15], v[48:63]
    v_exp_f32 v36, v36
    v_exp_f32 v37, v37
    v_exp_f32 v38, v38
    v_exp_f32 v39, v39
    ds_read_b128 v[88:91], v1 offset:32768
    ds_read_b128 v[92:95], v1 offset:33792
    v_cvt_pk_bf16_f32 v64, v32, v33
    v_cvt_pk_bf16_f32 v65, v34, v35
    v_cvt_pk_bf16_f32 v66, v36, v37
    v_cvt_pk_bf16_f32 v67, v38, v39
    v_exp_f32 v40, v40
    v_exp_f32 v41, v41
    v_mfma_f32_32x32x16_bf16 v[72:87], v[104:107], v[64:67], v[72:87]
    v_exp_f32 v42, v42
    v_exp_f32 v43, v43
    v_exp_f32 v44, v44
    v_mfma_f32_16x16x32_bf16 v[124:127], v[120:123], v[64:67], v[124:127]
    ds_read_b128 v[112:115], v1 offset:30720
    ds_read_b128 v[116:119], v1 offset:31744
    v_exp_f32 v45, v45
    v_exp_f32 v46, v46
    v_exp_f32 v47, v47
    s_add_u32 m0, s46, 0
    s_nop 0
    buffer_load_dwordx4 v1, s[20:23], s40 offen lds
    s_add_u32 m0, s46, 8192
    s_add_u32 s40, s40, 8192
    buffer_load_dwordx4 v1, s[20:23], s41 offen lds
    s_add_u32 s41, s41, 8192
    v_cvt_pk_bf16_f32 v68, v40, v41
    v_cvt_pk_bf16_f32 v69, v42, v43
    v_cvt_pk_bf16_f32 v70, v44, v45
    v_cvt_pk_bf16_f32 v71, v46, v47
    s_nop 1
    v_mfma_f32_32x32x16_bf16 v[72:87], v[108:111], v[68:71], v[72:87]
    v_mfma_f32_16x16x32_bf16 v[124:127], v[120:123], v[68:71], v[124:127]
    s_waitcnt lgkmcnt(0)
    v_mfma_f32_32x32x16_bf16 v[32:47], v[88:91], v[8:11], v[16:31]
    v_exp_f32 v48, v48
    v_exp_f32 v49, v49
    v_exp_f32 v50, v50
    v_exp_f32 v51, v51
    v_mfma_f32_32x32x16_bf16 v[32:47], v[92:95], v[12:15], v[32:47]
    v_exp_f32 v52, v52
    v_exp_f32 v53, v53
    v_exp_f32 v54, v54
    v_exp_f32 v55, v55
    ds_read_b128 v[96:99], v1 offset:34816
    ds_read_b128 v[100:103], v1 offset:35840
    v_cvt_pk_bf16_f32 v64, v48, v49
    v_cvt_pk_bf16_f32 v65, v50, v51
    v_cvt_pk_bf16_f32 v66, v52, v53
    v_cvt_pk_bf16_f32 v67, v54, v55
    v_exp_f32 v56, v56
    v_exp_f32 v57, v57
    v_mfma_f32_32x32x16_bf16 v[72:87], v[112:115], v[64:67], v[72:87]
    v_exp_f32 v58, v58
    v_exp_f32 v59, v59
    v_exp_f32 v60, v60
    v_mfma_f32_16x16x32_bf16 v[124:127], v[120:123], v[64:67], v[124:127]
    ds_read_b128 v[104:107], v1 offset:40960
    ds_read_b128 v[108:111], v1 offset:41984
    v_exp_f32 v61, v61
    v_exp_f32 v62, v62
    v_exp_f32 v63, v63
    s_mov_b32 s12, s24
    s_mov_b32 s13, s25
    s_mov_b32 s14, 0x700000
    s_mov_b32 s15, 0x00020000
    s_mov_b32 s16, s26
    s_mov_b32 s17, s27
    s_mov_b32 s18, 0x200000
    s_mov_b32 s19, 0x00020000
    s_lshl_b32 s45, s2, 3
    s_add_u32 s45, s45, s34
    s_mul_i32 s47, s45, 28
    v_add_u32 v3, s47, v0
    v_lshlrev_b32 v3, 7, v3
    s_mov_b64 exec, 0xfffffff
    buffer_load_dword v4, v3, s[12:15], 0 offen
    s_mov_b64 exec, -1
    s_lshl_b32 s47, s45, 3
    v_add_u32 v3, s47, v0
    v_lshlrev_b32 v3, 7, v3
    s_mov_b64 exec, 0xff
    buffer_load_dword v5, v3, s[16:19], 0 offen
    s_mov_b64 exec, -1
    v_cvt_pk_bf16_f32 v68, v56, v57
    v_cvt_pk_bf16_f32 v69, v58, v59
    v_cvt_pk_bf16_f32 v70, v60, v61
    v_cvt_pk_bf16_f32 v71, v62, v63
    s_nop 1
    v_mfma_f32_32x32x16_bf16 v[72:87], v[116:119], v[68:71], v[72:87]
    v_mfma_f32_16x16x32_bf16 v[124:127], v[120:123], v[68:71], v[124:127]
    s_waitcnt lgkmcnt(0)
    v_mfma_f32_32x32x16_bf16 v[48:63], v[96:99], v[8:11], v[16:31]
    v_exp_f32 v32, v32
    v_exp_f32 v33, v33
    v_exp_f32 v34, v34
    v_exp_f32 v35, v35
    v_mfma_f32_32x32x16_bf16 v[48:63], v[100:103], v[12:15], v[48:63]
    v_exp_f32 v36, v36
    v_exp_f32 v37, v37
    v_exp_f32 v38, v38
    v_exp_f32 v39, v39
    ds_read_b128 v[88:91], v1 offset:36864
    ds_read_b128 v[92:95], v1 offset:37888
    v_cvt_pk_bf16_f32 v64, v32, v33
    v_cvt_pk_bf16_f32 v65, v34, v35
    v_cvt_pk_bf16_f32 v66, v36, v37
    v_cvt_pk_bf16_f32 v67, v38, v39
    v_exp_f32 v40, v40
    v_exp_f32 v41, v41
    v_mfma_f32_32x32x16_bf16 v[72:87], v[104:107], v[64:67], v[72:87]
    v_exp_f32 v42, v42
    v_exp_f32 v43, v43
    v_exp_f32 v44, v44
    v_mfma_f32_16x16x32_bf16 v[124:127], v[120:123], v[64:67], v[124:127]
    ds_read_b128 v[112:115], v1 offset:43008
    ds_read_b128 v[116:119], v1 offset:44032
    v_exp_f32 v45, v45
    v_exp_f32 v46, v46
    v_exp_f32 v47, v47
    v_cvt_pk_bf16_f32 v68, v40, v41
    v_cvt_pk_bf16_f32 v69, v42, v43
    v_cvt_pk_bf16_f32 v70, v44, v45
    v_cvt_pk_bf16_f32 v71, v46, v47
    s_nop 1
    v_mfma_f32_32x32x16_bf16 v[72:87], v[108:111], v[68:71], v[72:87]
    v_mfma_f32_16x16x32_bf16 v[124:127], v[120:123], v[68:71], v[124:127]
    s_waitcnt lgkmcnt(0)
    v_mfma_f32_32x32x16_bf16 v[32:47], v[88:91], v[8:11], v[16:31]
    v_exp_f32 v48, v48
    v_exp_f32 v49, v49
    v_exp_f32 v50, v50
    v_exp_f32 v51, v51
    v_mfma_f32_32x32x16_bf16 v[32:47], v[92:95], v[12:15], v[32:47]
    v_exp_f32 v52, v52
    v_exp_f32 v53, v53
    v_exp_f32 v54, v54
    v_exp_f32 v55, v55
    ds_read_b128 v[96:99], v1 offset:38912
    ds_read_b128 v[100:103], v1 offset:39936
    v_cvt_pk_bf16_f32 v64, v48, v49
    v_cvt_pk_bf16_f32 v65, v50, v51
    v_cvt_pk_bf16_f32 v66, v52, v53
    v_cvt_pk_bf16_f32 v67, v54, v55
    v_exp_f32 v56, v56
    v_exp_f32 v57, v57
    v_mfma_f32_32x32x16_bf16 v[72:87], v[112:115], v[64:67], v[72:87]
    v_exp_f32 v58, v58
    v_exp_f32 v59, v59
    v_exp_f32 v60, v60
    v_mfma_f32_16x16x32_bf16 v[124:127], v[120:123], v[64:67], v[124:127]
    ds_read_b128 v[104:107], v1 offset:45056
    ds_read_b128 v[108:111], v1 offset:46080
    v_exp_f32 v61, v61
    v_exp_f32 v62, v62
    v_exp_f32 v63, v63
    v_cvt_pk_bf16_f32 v68, v56, v57
    v_cvt_pk_bf16_f32 v69, v58, v59
    v_cvt_pk_bf16_f32 v70, v60, v61
    v_cvt_pk_bf16_f32 v71, v62, v63
    s_nop 1
    v_mfma_f32_32x32x16_bf16 v[72:87], v[116:119], v[68:71], v[72:87]
    v_mfma_f32_16x16x32_bf16 v[124:127], v[120:123], v[68:71], v[124:127]
    s_waitcnt lgkmcnt(0)
    s_waitcnt vmcnt(2)
    s_barrier
    v_mfma_f32_32x32x16_bf16 v[48:63], v[96:99], v[8:11], v[16:31]
    v_exp_f32 v32, v32
    v_exp_f32 v33, v33
    v_exp_f32 v34, v34
    v_exp_f32 v35, v35
    v_mfma_f32_32x32x16_bf16 v[48:63], v[100:103], v[12:15], v[48:63]
    v_exp_f32 v36, v36
    v_exp_f32 v37, v37
    v_exp_f32 v38, v38
    v_exp_f32 v39, v39
    ds_read_b128 v[88:91], v1 offset:49152
    ds_read_b128 v[92:95], v1 offset:50176
    v_cvt_pk_bf16_f32 v64, v32, v33
    v_cvt_pk_bf16_f32 v65, v34, v35
    v_cvt_pk_bf16_f32 v66, v36, v37
    v_cvt_pk_bf16_f32 v67, v38, v39
    v_exp_f32 v40, v40
    v_exp_f32 v41, v41
    v_mfma_f32_32x32x16_bf16 v[72:87], v[104:107], v[64:67], v[72:87]
    v_exp_f32 v42, v42
    v_exp_f32 v43, v43
    v_exp_f32 v44, v44
    v_mfma_f32_16x16x32_bf16 v[124:127], v[120:123], v[64:67], v[124:127]
    ds_read_b128 v[112:115], v1 offset:47104
    ds_read_b128 v[116:119], v1 offset:48128
    v_exp_f32 v45, v45
    v_exp_f32 v46, v46
    v_exp_f32 v47, v47
    s_add_u32 m0, s46, 16384
    s_nop 0
    buffer_load_dwordx4 v1, s[20:23], s40 offen lds
    s_add_u32 m0, s46, 24576
    s_add_u32 s40, s40, 8192
    buffer_load_dwordx4 v1, s[20:23], s41 offen lds
    s_add_u32 s41, s41, 8192
    v_cvt_pk_bf16_f32 v68, v40, v41
    v_cvt_pk_bf16_f32 v69, v42, v43
    v_cvt_pk_bf16_f32 v70, v44, v45
    v_cvt_pk_bf16_f32 v71, v46, v47
    s_nop 1
    v_mfma_f32_32x32x16_bf16 v[72:87], v[108:111], v[68:71], v[72:87]
    v_mfma_f32_16x16x32_bf16 v[124:127], v[120:123], v[68:71], v[124:127]
    s_waitcnt lgkmcnt(0)
    v_mfma_f32_32x32x16_bf16 v[32:47], v[88:91], v[8:11], v[16:31]
    v_exp_f32 v48, v48
    v_exp_f32 v49, v49
    v_exp_f32 v50, v50
    v_exp_f32 v51, v51
    v_mfma_f32_32x32x16_bf16 v[32:47], v[92:95], v[12:15], v[32:47]
    v_exp_f32 v52, v52
    v_exp_f32 v53, v53
    v_exp_f32 v54, v54
    v_exp_f32 v55, v55
    ds_read_b128 v[96:99], v1 offset:51200
    ds_read_b128 v[100:103], v1 offset:52224
    v_cvt_pk_bf16_f32 v64, v48, v49
    v_cvt_pk_bf16_f32 v65, v50, v51
    v_cvt_pk_bf16_f32 v66, v52, v53
    v_cvt_pk_bf16_f32 v67, v54, v55
    v_exp_f32 v56, v56
    v_exp_f32 v57, v57
    v_mfma_f32_32x32x16_bf16 v[72:87], v[112:115], v[64:67], v[72:87]
    v_exp_f32 v58, v58
    v_exp_f32 v59, v59
    v_exp_f32 v60, v60
    v_mfma_f32_16x16x32_bf16 v[124:127], v[120:123], v[64:67], v[124:127]
    ds_read_b128 v[104:107], v1 offset:57344
    ds_read_b128 v[108:111], v1 offset:58368
    v_exp_f32 v61, v61
    v_exp_f32 v62, v62
    v_exp_f32 v63, v63
    v_cvt_pk_bf16_f32 v68, v56, v57
    v_cvt_pk_bf16_f32 v69, v58, v59
    v_cvt_pk_bf16_f32 v70, v60, v61
    v_cvt_pk_bf16_f32 v71, v62, v63
    s_nop 1
    v_mfma_f32_32x32x16_bf16 v[72:87], v[116:119], v[68:71], v[72:87]
    v_mfma_f32_16x16x32_bf16 v[124:127], v[120:123], v[68:71], v[124:127]
    s_waitcnt lgkmcnt(0)
    v_mfma_f32_32x32x16_bf16 v[48:63], v[96:99], v[8:11], v[16:31]
    v_exp_f32 v32, v32
    v_exp_f32 v33, v33
    v_exp_f32 v34, v34
    v_exp_f32 v35, v35
    v_mfma_f32_32x32x16_bf16 v[48:63], v[100:103], v[12:15], v[48:63]
    v_exp_f32 v36, v36
    v_exp_f32 v37, v37
    v_exp_f32 v38, v38
    v_exp_f32 v39, v39
    ds_read_b128 v[88:91], v1 offset:53248
    ds_read_b128 v[92:95], v1 offset:54272
    v_cvt_pk_bf16_f32 v64, v32, v33
    v_cvt_pk_bf16_f32 v65, v34, v35
    v_cvt_pk_bf16_f32 v66, v36, v37
    v_cvt_pk_bf16_f32 v67, v38, v39
    v_exp_f32 v40, v40
    v_exp_f32 v41, v41
    v_mfma_f32_32x32x16_bf16 v[72:87], v[104:107], v[64:67], v[72:87]
    v_exp_f32 v42, v42
    v_exp_f32 v43, v43
    v_exp_f32 v44, v44
    v_mfma_f32_16x16x32_bf16 v[124:127], v[120:123], v[64:67], v[124:127]
    ds_read_b128 v[112:115], v1 offset:59392
    ds_read_b128 v[116:119], v1 offset:60416
    v_exp_f32 v45, v45
    v_exp_f32 v46, v46
    v_exp_f32 v47, v47
    v_cvt_pk_bf16_f32 v68, v40, v41
    v_cvt_pk_bf16_f32 v69, v42, v43
    v_cvt_pk_bf16_f32 v70, v44, v45
    v_cvt_pk_bf16_f32 v71, v46, v47
    s_nop 1
    v_mfma_f32_32x32x16_bf16 v[72:87], v[108:111], v[68:71], v[72:87]
    v_mfma_f32_16x16x32_bf16 v[124:127], v[120:123], v[68:71], v[124:127]
    s_waitcnt lgkmcnt(0)
    v_mfma_f32_32x32x16_bf16 v[32:47], v[88:91], v[8:11], v[16:31]
    v_exp_f32 v48, v48
    v_exp_f32 v49, v49
    v_exp_f32 v50, v50
    v_exp_f32 v51, v51
    v_mfma_f32_32x32x16_bf16 v[32:47], v[92:95], v[12:15], v[32:47]
    v_exp_f32 v52, v52
    v_exp_f32 v53, v53
    v_exp_f32 v54, v54
    v_exp_f32 v55, v55
    ds_read_b128 v[96:99], v1 offset:55296
    ds_read_b128 v[100:103], v1 offset:56320
    v_cvt_pk_bf16_f32 v64, v48, v49
    v_cvt_pk_bf16_f32 v65, v50, v51
    v_cvt_pk_bf16_f32 v66, v52, v53
    v_cvt_pk_bf16_f32 v67, v54, v55
    v_exp_f32 v56, v56
    v_exp_f32 v57, v57
    v_mfma_f32_32x32x16_bf16 v[72:87], v[112:115], v[64:67], v[72:87]
    v_exp_f32 v58, v58
    v_exp_f32 v59, v59
    v_exp_f32 v60, v60
    v_mfma_f32_16x16x32_bf16 v[124:127], v[120:123], v[64:67], v[124:127]
    ds_read_b128 v[104:107], v1 offset:61440
    ds_read_b128 v[108:111], v1 offset:62464
    v_exp_f32 v61, v61
    v_exp_f32 v62, v62
    v_exp_f32 v63, v63
    v_cvt_pk_bf16_f32 v68, v56, v57
    v_cvt_pk_bf16_f32 v69, v58, v59
    v_cvt_pk_bf16_f32 v70, v60, v61
    v_cvt_pk_bf16_f32 v71, v62, v63
    s_nop 1
    v_mfma_f32_32x32x16_bf16 v[72:87], v[116:119], v[68:71], v[72:87]
    v_mfma_f32_16x16x32_bf16 v[124:127], v[120:123], v[68:71], v[124:127]
    s_waitcnt lgkmcnt(0)
    s_waitcnt vmcnt(2)
    s_barrier
    v_mfma_f32_32x32x16_bf16 v[48:63], v[96:99], v[8:11], v[16:31]
    v_exp_f32 v32, v32
    v_exp_f32 v33, v33
    v_exp_f32 v34, v34
    v_exp_f32 v35, v35
    v_mfma_f32_32x32x16_bf16 v[48:63], v[100:103], v[12:15], v[48:63]
    v_exp_f32 v36, v36
    v_exp_f32 v37, v37
    v_exp_f32 v38, v38
    v_exp_f32 v39, v39
    ds_read_b128 v[88:91], v1 offset:0
    ds_read_b128 v[92:95], v1 offset:1024
    v_cvt_pk_bf16_f32 v64, v32, v33
    v_cvt_pk_bf16_f32 v65, v34, v35
    v_cvt_pk_bf16_f32 v66, v36, v37
    v_cvt_pk_bf16_f32 v67, v38, v39
    v_exp_f32 v40, v40
    v_exp_f32 v41, v41
    v_mfma_f32_32x32x16_bf16 v[72:87], v[104:107], v[64:67], v[72:87]
    v_exp_f32 v42, v42
    v_exp_f32 v43, v43
    v_exp_f32 v44, v44
    v_mfma_f32_16x16x32_bf16 v[124:127], v[120:123], v[64:67], v[124:127]
    ds_read_b128 v[112:115], v1 offset:63488
    ds_read_b128 v[116:119], v1 offset:64512
    v_exp_f32 v45, v45
    v_exp_f32 v46, v46
    v_exp_f32 v47, v47
    s_add_u32 m0, s46, 32768
    s_nop 0
    buffer_load_dwordx4 v1, s[20:23], s40 offen lds
    s_add_u32 m0, s46, 40960
    s_add_u32 s40, s40, 8192
    buffer_load_dwordx4 v1, s[20:23], s41 offen lds
    s_add_u32 s41, s41, 8192
    v_cvt_pk_bf16_f32 v68, v40, v41
    v_cvt_pk_bf16_f32 v69, v42, v43
    v_cvt_pk_bf16_f32 v70, v44, v45
    v_cvt_pk_bf16_f32 v71, v46, v47
    s_nop 1
    v_mfma_f32_32x32x16_bf16 v[72:87], v[108:111], v[68:71], v[72:87]
    v_mfma_f32_16x16x32_bf16 v[124:127], v[120:123], v[68:71], v[124:127]
    s_waitcnt lgkmcnt(0)
    v_mfma_f32_32x32x16_bf16 v[32:47], v[88:91], v[8:11], v[16:31]
    v_exp_f32 v48, v48
    v_exp_f32 v49, v49
    v_exp_f32 v50, v50
    v_exp_f32 v51, v51
    v_mfma_f32_32x32x16_bf16 v[32:47], v[92:95], v[12:15], v[32:47]
    v_exp_f32 v52, v52
    v_exp_f32 v53, v53
    v_exp_f32 v54, v54
    v_exp_f32 v55, v55
    ds_read_b128 v[96:99], v1 offset:2048
    ds_read_b128 v[100:103], v1 offset:3072
    v_cvt_pk_bf16_f32 v64, v48, v49
    v_cvt_pk_bf16_f32 v65, v50, v51
    v_cvt_pk_bf16_f32 v66, v52, v53
    v_cvt_pk_bf16_f32 v67, v54, v55
    v_exp_f32 v56, v56
    v_exp_f32 v57, v57
    v_mfma_f32_32x32x16_bf16 v[72:87], v[112:115], v[64:67], v[72:87]
    v_exp_f32 v58, v58
    v_exp_f32 v59, v59
    v_exp_f32 v60, v60
    v_mfma_f32_16x16x32_bf16 v[124:127], v[120:123], v[64:67], v[124:127]
    ds_read_b128 v[104:107], v1 offset:8192
    ds_read_b128 v[108:111], v1 offset:9216
    v_exp_f32 v61, v61
    v_exp_f32 v62, v62
    v_exp_f32 v63, v63
    v_cvt_pk_bf16_f32 v68, v56, v57
    v_cvt_pk_bf16_f32 v69, v58, v59
    v_cvt_pk_bf16_f32 v70, v60, v61
    v_cvt_pk_bf16_f32 v71, v62, v63
    s_nop 1
    v_mfma_f32_32x32x16_bf16 v[72:87], v[116:119], v[68:71], v[72:87]
    v_mfma_f32_16x16x32_bf16 v[124:127], v[120:123], v[68:71], v[124:127]
    s_waitcnt lgkmcnt(0)
    s_mov_b32 s44, 2
L_k2_loop:
    v_mfma_f32_32x32x16_bf16 v[48:63], v[96:99], v[8:11], v[16:31]
    v_exp_f32 v32, v32
    v_exp_f32 v33, v33
    v_exp_f32 v34, v34
    v_exp_f32 v35, v35
    v_mfma_f32_32x32x16_bf16 v[48:63], v[100:103], v[12:15], v[48:63]
    v_exp_f32 v36, v36
    v_exp_f32 v37, v37
    v_exp_f32 v38, v38
    v_exp_f32 v39, v39
    ds_read_b128 v[88:91], v1 offset:4096
    ds_read_b128 v[92:95], v1 offset:5120
    v_cvt_pk_bf16_f32 v64, v32, v33
    v_cvt_pk_bf16_f32 v65, v34, v35
    v_cvt_pk_bf16_f32 v66, v36, v37
    v_cvt_pk_bf16_f32 v67, v38, v39
    v_exp_f32 v40, v40
    v_exp_f32 v41, v41
    v_mfma_f32_32x32x16_bf16 v[72:87], v[104:107], v[64:67], v[72:87]
    v_exp_f32 v42, v42
    v_exp_f32 v43, v43
    v_exp_f32 v44, v44
    v_mfma_f32_16x16x32_bf16 v[124:127], v[120:123], v[64:67], v[124:127]
    ds_read_b128 v[112:115], v1 offset:10240
    ds_read_b128 v[116:119], v1 offset:11264
    v_exp_f32 v45, v45
    v_exp_f32 v46, v46
    v_exp_f32 v47, v47
    v_cvt_pk_bf16_f32 v68, v40, v41
    v_cvt_pk_bf16_f32 v69, v42, v43
    v_cvt_pk_bf16_f32 v70, v44, v45
    v_cvt_pk_bf16_f32 v71, v46, v47
    s_nop 1
    v_mfma_f32_32x32x16_bf16 v[72:87], v[108:111], v[68:71], v[72:87]
    v_mfma_f32_16x16x32_bf16 v[124:127], v[120:123], v[68:71], v[124:127]
    s_waitcnt lgkmcnt(0)
    v_mfma_f32_32x32x16_bf16 v[32:47], v[88:91], v[8:11], v[16:31]
    v_exp_f32 v48, v48
    v_exp_f32 v49, v49
    v_exp_f32 v50, v50
    v_exp_f32 v51, v51
    v_mfma_f32_32x32x16_bf16 v[32:47], v[92:95], v[12:15], v[32:47]
    v_exp_f32 v52, v52
    v_exp_f32 v53, v53
    v_exp_f32 v54, v54
    v_exp_f32 v55, v55
    ds_read_b128 v[96:99], v1 offset:6144
    ds_read_b128 v[100:103], v1 offset:7168
    v_cvt_pk_bf16_f32 v64, v48, v49
    v_cvt_pk_bf16_f32 v65, v50, v51
    v_cvt_pk_bf16_f32 v66, v52, v53
    v_cvt_pk_bf16_f32 v67, v54, v55
    v_exp_f32 v56, v56
    v_exp_f32 v57, v57
    v_mfma_f32_32x32x16_bf16 v[72:87], v[112:115], v[64:67], v[72:87]
    v_exp_f32 v58, v58
    v_exp_f32 v59, v59
    v_exp_f32 v60, v60
    v_mfma_f32_16x16x32_bf16 v[124:127], v[120:123], v[64:67], v[124:127]
    ds_read_b128 v[104:107], v1 offset:12288
    ds_read_b128 v[108:111], v1 offset:13312
    v_exp_f32 v61, v61
    v_exp_f32 v62, v62
    v_exp_f32 v63, v63
    v_cvt_pk_bf16_f32 v68, v56, v57
    v_cvt_pk_bf16_f32 v69, v58, v59
    v_cvt_pk_bf16_f32 v70, v60, v61
    v_cvt_pk_bf16_f32 v71, v62, v63
    s_nop 1
    v_mfma_f32_32x32x16_bf16 v[72:87], v[116:119], v[68:71], v[72:87]
    v_mfma_f32_16x16x32_bf16 v[124:127], v[120:123], v[68:71], v[124:127]
    s_waitcnt lgkmcnt(0)
    s_waitcnt vmcnt(2)
    s_barrier
    v_mfma_f32_32x32x16_bf16 v[48:63], v[96:99], v[8:11], v[16:31]
    v_exp_f32 v32, v32
    v_exp_f32 v33, v33
    v_exp_f32 v34, v34
    v_exp_f32 v35, v35
    v_mfma_f32_32x32x16_bf16 v[48:63], v[100:103], v[12:15], v[48:63]
    v_exp_f32 v36, v36
    v_exp_f32 v37, v37
    v_exp_f32 v38, v38
    v_exp_f32 v39, v39
    ds_read_b128 v[88:91], v1 offset:16384
    ds_read_b128 v[92:95], v1 offset:17408
    v_cvt_pk_bf16_f32 v64, v32, v33
    v_cvt_pk_bf16_f32 v65, v34, v35
    v_cvt_pk_bf16_f32 v66, v36, v37
    v_cvt_pk_bf16_f32 v67, v38, v39
    v_exp_f32 v40, v40
    v_exp_f32 v41, v41
    v_mfma_f32_32x32x16_bf16 v[72:87], v[104:107], v[64:67], v[72:87]
    v_exp_f32 v42, v42
    v_exp_f32 v43, v43
    v_exp_f32 v44, v44
    v_mfma_f32_16x16x32_bf16 v[124:127], v[120:123], v[64:67], v[124:127]
    ds_read_b128 v[112:115], v1 offset:14336
    ds_read_b128 v[116:119], v1 offset:15360
    v_exp_f32 v45, v45
    v_exp_f32 v46, v46
    v_exp_f32 v47, v47
    s_add_u32 m0, s46, 49152
    s_nop 0
    buffer_load_dwordx4 v1, s[20:23], s40 offen lds
    s_add_u32 m0, s46, 57344
    s_add_u32 s40, s40, 8192
    buffer_load_dwordx4 v1, s[20:23], s41 offen lds
    s_add_u32 s41, s41, 8192
    v_cvt_pk_bf16_f32 v68, v40, v41
    v_cvt_pk_bf16_f32 v69, v42, v43
    v_cvt_pk_bf16_f32 v70, v44, v45
    v_cvt_pk_bf16_f32 v71, v46, v47
    s_nop 1
    v_mfma_f32_32x32x16_bf16 v[72:87], v[108:111], v[68:71], v[72:87]
    v_mfma_f32_16x16x32_bf16 v[124:127], v[120:123], v[68:71], v[124:127]
    s_waitcnt lgkmcnt(0)
    v_mfma_f32_32x32x16_bf16 v[32:47], v[88:91], v[8:11], v[16:31]
    v_exp_f32 v48, v48
    v_exp_f32 v49, v49
    v_exp_f32 v50, v50
    v_exp_f32 v51, v51
    v_mfma_f32_32x32x16_bf16 v[32:47], v[92:95], v[12:15], v[32:47]
    v_exp_f32 v52, v52
    v_exp_f32 v53, v53
    v_exp_f32 v54, v54
    v_exp_f32 v55, v55
    ds_read_b128 v[96:99], v1 offset:18432
    ds_read_b128 v[100:103], v1 offset:19456
    v_cvt_pk_bf16_f32 v64, v48, v49
    v_cvt_pk_bf16_f32 v65, v50, v51
    v_cvt_pk_bf16_f32 v66, v52, v53
    v_cvt_pk_bf16_f32 v67, v54, v55
    v_exp_f32 v56, v56
    v_exp_f32 v57, v57
    v_mfma_f32_32x32x16_bf16 v[72:87], v[112:115], v[64:67], v[72:87]
    v_exp_f32 v58, v58
    v_exp_f32 v59, v59
    v_exp_f32 v60, v60
    v_mfma_f32_16x16x32_bf16 v[124:127], v[120:123], v[64:67], v[124:127]
    ds_read_b128 v[104:107], v1 offset:24576
    ds_read_b128 v[108:111], v1 offset:25600
    v_exp_f32 v61, v61
    v_exp_f32 v62, v62
    v_exp_f32 v63, v63
    v_cvt_pk_bf16_f32 v68, v56, v57
    v_cvt_pk_bf16_f32 v69, v58, v59
    v_cvt_pk_bf16_f32 v70, v60, v61
    v_cvt_pk_bf16_f32 v71, v62, v63
    s_nop 1
    v_mfma_f32_32x32x16_bf16 v[72:87], v[116:119], v[68:71], v[72:87]
    v_mfma_f32_16x16x32_bf16 v[124:127], v[120:123], v[68:71], v[124:127]
    s_waitcnt lgkmcnt(0)
    v_mfma_f32_32x32x16_bf16 v[48:63], v[96:99], v[8:11], v[16:31]
    v_exp_f32 v32, v32
    v_exp_f32 v33, v33
    v_exp_f32 v34, v34
    v_exp_f32 v35, v35
    v_mfma_f32_32x32x16_bf16 v[48:63], v[100:103], v[12:15], v[48:63]
    v_exp_f32 v36, v36
    v_exp_f32 v37, v37
    v_exp_f32 v38, v38
    v_exp_f32 v39, v39
    ds_read_b128 v[88:91], v1 offset:20480
    ds_read_b128 v[92:95], v1 offset:21504
    v_cvt_pk_bf16_f32 v64, v32, v33
    v_cvt_pk_bf16_f32 v65, v34, v35
    v_cvt_pk_bf16_f32 v66, v36, v37
    v_cvt_pk_bf16_f32 v67, v38, v39
    v_exp_f32 v40, v40
    v_exp_f32 v41, v41
    v_mfma_f32_32x32x16_bf16 v[72:87], v[104:107], v[64:67], v[72:87]
    v_exp_f32 v42, v42
    v_exp_f32 v43, v43
    v_exp_f32 v44, v44
    v_mfma_f32_16x16x32_bf16 v[124:127], v[120:123], v[64:67], v[124:127]
    ds_read_b128 v[112:115], v1 offset:26624
    ds_read_b128 v[116:119], v1 offset:27648
    v_exp_f32 v45, v45
    v_exp_f32 v46, v46
    v_exp_f32 v47, v47
    v_cvt_pk_bf16_f32 v68, v40, v41
    v_cvt_pk_bf16_f32 v69, v42, v43
    v_cvt_pk_bf16_f32 v70, v44, v45
    v_cvt_pk_bf16_f32 v71, v46, v47
    s_nop 1
    v_mfma_f32_32x32x16_bf16 v[72:87], v[108:111], v[68:71], v[72:87]
    v_mfma_f32_16x16x32_bf16 v[124:127], v[120:123], v[68:71], v[124:127]
    s_waitcnt lgkmcnt(0)
    v_mfma_f32_32x32x16_bf16 v[32:47], v[88:91], v[8:11], v[16:31]
    v_exp_f32 v48, v48
    v_exp_f32 v49, v49
    v_exp_f32 v50, v50
    v_exp_f32 v51, v51
    v_mfma_f32_32x32x16_bf16 v[32:47], v[92:95], v[12:15], v[32:47]
    v_exp_f32 v52, v52
    v_exp_f32 v53, v53
    v_exp_f32 v54, v54
    v_exp_f32 v55, v55
    ds_read_b128 v[96:99], v1 offset:22528
    ds_read_b128 v[100:103], v1 offset:23552
    v_cvt_pk_bf16_f32 v64, v48, v49
    v_cvt_pk_bf16_f32 v65, v50, v51
    v_cvt_pk_bf16_f32 v66, v52, v53
    v_cvt_pk_bf16_f32 v67, v54, v55
    v_exp_f32 v56, v56
    v_exp_f32 v57, v57
    v_mfma_f32_32x32x16_bf16 v[72:87], v[112:115], v[64:67], v[72:87]
    v_exp_f32 v58, v58
    v_exp_f32 v59, v59
    v_exp_f32 v60, v60
    v_mfma_f32_16x16x32_bf16 v[124:127], v[120:123], v[64:67], v[124:127]
    ds_read_b128 v[104:107], v1 offset:28672
    ds_read_b128 v[108:111], v1 offset:29696
    v_exp_f32 v61, v61
    v_exp_f32 v62, v62
    v_exp_f32 v63, v63
    v_cvt_pk_bf16_f32 v68, v56, v57
    v_cvt_pk_bf16_f32 v69, v58, v59
    v_cvt_pk_bf16_f32 v70, v60, v61
    v_cvt_pk_bf16_f32 v71, v62, v63
    s_nop 1
    v_mfma_f32_32x32x16_bf16 v[72:87], v[116:119], v[68:71], v[72:87]
    v_mfma_f32_16x16x32_bf16 v[124:127], v[120:123], v[68:71], v[124:127]
    s_waitcnt lgkmcnt(0)
    s_waitcnt vmcnt(2)
    s_barrier
    v_mfma_f32_32x32x16_bf16 v[48:63], v[96:99], v[8:11], v[16:31]
    v_exp_f32 v32, v32
    v_exp_f32 v33, v33
    v_exp_f32 v34, v34
    v_exp_f32 v35, v35
    v_mfma_f32_32x32x16_bf16 v[48:63], v[100:103], v[12:15], v[48:63]
    v_exp_f32 v36, v36
    v_exp_f32 v37, v37
    v_exp_f32 v38, v38
    v_exp_f32 v39, v39
    ds_read_b128 v[88:91], v1 offset:32768
    ds_read_b128 v[92:95], v1 offset:33792
    v_cvt_pk_bf16_f32 v64, v32, v33
    v_cvt_pk_bf16_f32 v65, v34, v35
    v_cvt_pk_bf16_f32 v66, v36, v37
    v_cvt_pk_bf16_f32 v67, v38, v39
    v_exp_f32 v40, v40
    v_exp_f32 v41, v41
    v_mfma_f32_32x32x16_bf16 v[72:87], v[104:107], v[64:67], v[72:87]
    v_exp_f32 v42, v42
    v_exp_f32 v43, v43
    v_exp_f32 v44, v44
    v_mfma_f32_16x16x32_bf16 v[124:127], v[120:123], v[64:67], v[124:127]
    ds_read_b128 v[112:115], v1 offset:30720
    ds_read_b128 v[116:119], v1 offset:31744
    v_exp_f32 v45, v45
    v_exp_f32 v46, v46
    v_exp_f32 v47, v47
    s_add_u32 m0, s46, 0
    s_nop 0
    buffer_load_dwordx4 v1, s[20:23], s40 offen lds
    s_add_u32 m0, s46, 8192
    s_add_u32 s40, s40, 8192
    buffer_load_dwordx4 v1, s[20:23], s41 offen lds
    s_add_u32 s41, s41, 8192
    v_cvt_pk_bf16_f32 v68, v40, v41
    v_cvt_pk_bf16_f32 v69, v42, v43
    v_cvt_pk_bf16_f32 v70, v44, v45
    v_cvt_pk_bf16_f32 v71, v46, v47
    s_nop 1
    v_mfma_f32_32x32x16_bf16 v[72:87], v[108:111], v[68:71], v[72:87]
    v_mfma_f32_16x16x32_bf16 v[124:127], v[120:123], v[68:71], v[124:127]
    s_waitcnt lgkmcnt(0)
    v_mfma_f32_32x32x16_bf16 v[32:47], v[88:91], v[8:11], v[16:31]
    v_exp_f32 v48, v48
    v_exp_f32 v49, v49
    v_exp_f32 v50, v50
    v_exp_f32 v51, v51
    v_mfma_f32_32x32x16_bf16 v[32:47], v[92:95], v[12:15], v[32:47]
    v_exp_f32 v52, v52
    v_exp_f32 v53, v53
    v_exp_f32 v54, v54
    v_exp_f32 v55, v55
    ds_read_b128 v[96:99], v1 offset:34816
    ds_read_b128 v[100:103], v1 offset:35840
    v_cvt_pk_bf16_f32 v64, v48, v49
    v_cvt_pk_bf16_f32 v65, v50, v51
    v_cvt_pk_bf16_f32 v66, v52, v53
    v_cvt_pk_bf16_f32 v67, v54, v55
    v_exp_f32 v56, v56
    v_exp_f32 v57, v57
    v_mfma_f32_32x32x16_bf16 v[72:87], v[112:115], v[64:67], v[72:87]
    v_exp_f32 v58, v58
    v_exp_f32 v59, v59
    v_exp_f32 v60, v60
    v_mfma_f32_16x16x32_bf16 v[124:127], v[120:123], v[64:67], v[124:127]
    ds_read_b128 v[104:107], v1 offset:40960
    ds_read_b128 v[108:111], v1 offset:41984
    v_exp_f32 v61, v61
    v_exp_f32 v62, v62
    v_exp_f32 v63, v63
    v_cvt_pk_bf16_f32 v68, v56, v57
    v_cvt_pk_bf16_f32 v69, v58, v59
    v_cvt_pk_bf16_f32 v70, v60, v61
    v_cvt_pk_bf16_f32 v71, v62, v63
    s_nop 1
    v_mfma_f32_32x32x16_bf16 v[72:87], v[116:119], v[68:71], v[72:87]
    v_mfma_f32_16x16x32_bf16 v[124:127], v[120:123], v[68:71], v[124:127]
    s_waitcnt lgkmcnt(0)
    v_mfma_f32_32x32x16_bf16 v[48:63], v[96:99], v[8:11], v[16:31]
    v_exp_f32 v32, v32
    v_exp_f32 v33, v33
    v_exp_f32 v34, v34
    v_exp_f32 v35, v35
    v_mfma_f32_32x32x16_bf16 v[48:63], v[100:103], v[12:15], v[48:63]
    v_exp_f32 v36, v36
    v_exp_f32 v37, v37
    v_exp_f32 v38, v38
    v_exp_f32 v39, v39
    ds_read_b128 v[88:91], v1 offset:36864
    ds_read_b128 v[92:95], v1 offset:37888
    v_cvt_pk_bf16_f32 v64, v32, v33
    v_cvt_pk_bf16_f32 v65, v34, v35
    v_cvt_pk_bf16_f32 v66, v36, v37
    v_cvt_pk_bf16_f32 v67, v38, v39
    v_exp_f32 v40, v40
    v_exp_f32 v41, v41
    v_mfma_f32_32x32x16_bf16 v[72:87], v[104:107], v[64:67], v[72:87]
    v_exp_f32 v42, v42
    v_exp_f32 v43, v43
    v_exp_f32 v44, v44
    v_mfma_f32_16x16x32_bf16 v[124:127], v[120:123], v[64:67], v[124:127]
    ds_read_b128 v[112:115], v1 offset:43008
    ds_read_b128 v[116:119], v1 offset:44032
    v_exp_f32 v45, v45
    v_exp_f32 v46, v46
    v_exp_f32 v47, v47
    v_cvt_pk_bf16_f32 v68, v40, v41
    v_cvt_pk_bf16_f32 v69, v42, v43
    v_cvt_pk_bf16_f32 v70, v44, v45
    v_cvt_pk_bf16_f32 v71, v46, v47
    s_nop 1
    v_mfma_f32_32x32x16_bf16 v[72:87], v[108:111], v[68:71], v[72:87]
    v_mfma_f32_16x16x32_bf16 v[124:127], v[120:123], v[68:71], v[124:127]
    s_waitcnt lgkmcnt(0)
    v_mfma_f32_32x32x16_bf16 v[32:47], v[88:91], v[8:11], v[16:31]
    v_exp_f32 v48, v48
    v_exp_f32 v49, v49
    v_exp_f32 v50, v50
    v_exp_f32 v51, v51
    v_mfma_f32_32x32x16_bf16 v[32:47], v[92:95], v[12:15], v[32:47]
    v_exp_f32 v52, v52
    v_exp_f32 v53, v53
    v_exp_f32 v54, v54
    v_exp_f32 v55, v55
    ds_read_b128 v[96:99], v1 offset:38912
    ds_read_b128 v[100:103], v1 offset:39936
    v_cvt_pk_bf16_f32 v64, v48, v49
    v_cvt_pk_bf16_f32 v65, v50, v51
    v_cvt_pk_bf16_f32 v66, v52, v53
    v_cvt_pk_bf16_f32 v67, v54, v55
    v_exp_f32 v56, v56
    v_exp_f32 v57, v57
    v_mfma_f32_32x32x16_bf16 v[72:87], v[112:115], v[64:67], v[72:87]
    v_exp_f32 v58, v58
    v_exp_f32 v59, v59
    v_exp_f32 v60, v60
    v_mfma_f32_16x16x32_bf16 v[124:127], v[120:123], v[64:67], v[124:127]
    ds_read_b128 v[104:107], v1 offset:45056
    ds_read_b128 v[108:111], v1 offset:46080
    v_exp_f32 v61, v61
    v_exp_f32 v62, v62
    v_exp_f32 v63, v63
    v_cvt_pk_bf16_f32 v68, v56, v57
    v_cvt_pk_bf16_f32 v69, v58, v59
    v_cvt_pk_bf16_f32 v70, v60, v61
    v_cvt_pk_bf16_f32 v71, v62, v63
    s_nop 1
    v_mfma_f32_32x32x16_bf16 v[72:87], v[116:119], v[68:71], v[72:87]
    v_mfma_f32_16x16x32_bf16 v[124:127], v[120:123], v[68:71], v[124:127]
    s_waitcnt lgkmcnt(0)
    s_waitcnt vmcnt(2)
    s_barrier
    v_mfma_f32_32x32x16_bf16 v[48:63], v[96:99], v[8:11], v[16:31]
    v_exp_f32 v32, v32
    v_exp_f32 v33, v33
    v_exp_f32 v34, v34
    v_exp_f32 v35, v35
    v_mfma_f32_32x32x16_bf16 v[48:63], v[100:103], v[12:15], v[48:63]
    v_exp_f32 v36, v36
    v_exp_f32 v37, v37
    v_exp_f32 v38, v38
    v_exp_f32 v39, v39
    ds_read_b128 v[88:91], v1 offset:49152
    ds_read_b128 v[92:95], v1 offset:50176
    v_cvt_pk_bf16_f32 v64, v32, v33
    v_cvt_pk_bf16_f32 v65, v34, v35
    v_cvt_pk_bf16_f32 v66, v36, v37
    v_cvt_pk_bf16_f32 v67, v38, v39
    v_exp_f32 v40, v40
    v_exp_f32 v41, v41
    v_mfma_f32_32x32x16_bf16 v[72:87], v[104:107], v[64:67], v[72:87]
    v_exp_f32 v42, v42
    v_exp_f32 v43, v43
    v_exp_f32 v44, v44
    v_mfma_f32_16x16x32_bf16 v[124:127], v[120:123], v[64:67], v[124:127]
    ds_read_b128 v[112:115], v1 offset:47104
    ds_read_b128 v[116:119], v1 offset:48128
    v_exp_f32 v45, v45
    v_exp_f32 v46, v46
    v_exp_f32 v47, v47
    s_add_u32 m0, s46, 16384
    s_nop 0
    buffer_load_dwordx4 v1, s[20:23], s40 offen lds
    s_add_u32 m0, s46, 24576
    s_add_u32 s40, s40, 8192
    buffer_load_dwordx4 v1, s[20:23], s41 offen lds
    s_add_u32 s41, s41, 8192
    v_cvt_pk_bf16_f32 v68, v40, v41
    v_cvt_pk_bf16_f32 v69, v42, v43
    v_cvt_pk_bf16_f32 v70, v44, v45
    v_cvt_pk_bf16_f32 v71, v46, v47
    s_nop 1
    v_mfma_f32_32x32x16_bf16 v[72:87], v[108:111], v[68:71], v[72:87]
    v_mfma_f32_16x16x32_bf16 v[124:127], v[120:123], v[68:71], v[124:127]
    s_waitcnt lgkmcnt(0)
    v_mfma_f32_32x32x16_bf16 v[32:47], v[88:91], v[8:11], v[16:31]
    v_exp_f32 v48, v48
    v_exp_f32 v49, v49
    v_exp_f32 v50, v50
    v_exp_f32 v51, v51
    v_mfma_f32_32x32x16_bf16 v[32:47], v[92:95], v[12:15], v[32:47]
    v_exp_f32 v52, v52
    v_exp_f32 v53, v53
    v_exp_f32 v54, v54
    v_exp_f32 v55, v55
    ds_read_b128 v[96:99], v1 offset:51200
    ds_read_b128 v[100:103], v1 offset:52224
    v_cvt_pk_bf16_f32 v64, v48, v49
    v_cvt_pk_bf16_f32 v65, v50, v51
    v_cvt_pk_bf16_f32 v66, v52, v53
    v_cvt_pk_bf16_f32 v67, v54, v55
    v_exp_f32 v56, v56
    v_exp_f32 v57, v57
    v_mfma_f32_32x32x16_bf16 v[72:87], v[112:115], v[64:67], v[72:87]
    v_exp_f32 v58, v58
    v_exp_f32 v59, v59
    v_exp_f32 v60, v60
    v_mfma_f32_16x16x32_bf16 v[124:127], v[120:123], v[64:67], v[124:127]
    ds_read_b128 v[104:107], v1 offset:57344
    ds_read_b128 v[108:111], v1 offset:58368
    v_exp_f32 v61, v61
    v_exp_f32 v62, v62
    v_exp_f32 v63, v63
    v_cvt_pk_bf16_f32 v68, v56, v57
    v_cvt_pk_bf16_f32 v69, v58, v59
    v_cvt_pk_bf16_f32 v70, v60, v61
    v_cvt_pk_bf16_f32 v71, v62, v63
    s_nop 1
    v_mfma_f32_32x32x16_bf16 v[72:87], v[116:119], v[68:71], v[72:87]
    v_mfma_f32_16x16x32_bf16 v[124:127], v[120:123], v[68:71], v[124:127]
    s_waitcnt lgkmcnt(0)
    v_mfma_f32_32x32x16_bf16 v[48:63], v[96:99], v[8:11], v[16:31]
    v_exp_f32 v32, v32
    v_exp_f32 v33, v33
    v_exp_f32 v34, v34
    v_exp_f32 v35, v35
    v_mfma_f32_32x32x16_bf16 v[48:63], v[100:103], v[12:15], v[48:63]
    v_exp_f32 v36, v36
    v_exp_f32 v37, v37
    v_exp_f32 v38, v38
    v_exp_f32 v39, v39
    ds_read_b128 v[88:91], v1 offset:53248
    ds_read_b128 v[92:95], v1 offset:54272
    v_cvt_pk_bf16_f32 v64, v32, v33
    v_cvt_pk_bf16_f32 v65, v34, v35
    v_cvt_pk_bf16_f32 v66, v36, v37
    v_cvt_pk_bf16_f32 v67, v38, v39
    v_exp_f32 v40, v40
    v_exp_f32 v41, v41
    v_mfma_f32_32x32x16_bf16 v[72:87], v[104:107], v[64:67], v[72:87]
    v_exp_f32 v42, v42
    v_exp_f32 v43, v43
    v_exp_f32 v44, v44
    v_mfma_f32_16x16x32_bf16 v[124:127], v[120:123], v[64:67], v[124:127]
    ds_read_b128 v[112:115], v1 offset:59392
    ds_read_b128 v[116:119], v1 offset:60416
    v_exp_f32 v45, v45
    v_exp_f32 v46, v46
    v_exp_f32 v47, v47
    v_cvt_pk_bf16_f32 v68, v40, v41
    v_cvt_pk_bf16_f32 v69, v42, v43
    v_cvt_pk_bf16_f32 v70, v44, v45
    v_cvt_pk_bf16_f32 v71, v46, v47
    s_nop 1
    v_mfma_f32_32x32x16_bf16 v[72:87], v[108:111], v[68:71], v[72:87]
    v_mfma_f32_16x16x32_bf16 v[124:127], v[120:123], v[68:71], v[124:127]
    s_waitcnt lgkmcnt(0)
    v_mfma_f32_32x32x16_bf16 v[32:47], v[88:91], v[8:11], v[16:31]
    v_exp_f32 v48, v48
    v_exp_f32 v49, v49
    v_exp_f32 v50, v50
    v_exp_f32 v51, v51
    v_mfma_f32_32x32x16_bf16 v[32:47], v[92:95], v[12:15], v[32:47]
    v_exp_f32 v52, v52
    v_exp_f32 v53, v53
    v_exp_f32 v54, v54
    v_exp_f32 v55, v55
    ds_read_b128 v[96:99], v1 offset:55296
    ds_read_b128 v[100:103], v1 offset:56320
    v_cvt_pk_bf16_f32 v64, v48, v49
    v_cvt_pk_bf16_f32 v65, v50, v51
    v_cvt_pk_bf16_f32 v66, v52, v53
    v_cvt_pk_bf16_f32 v67, v54, v55
    v_exp_f32 v56, v56
    v_exp_f32 v57, v57
    v_mfma_f32_32x32x16_bf16 v[72:87], v[112:115], v[64:67], v[72:87]
    v_exp_f32 v58, v58
    v_exp_f32 v59, v59
    v_exp_f32 v60, v60
    v_mfma_f32_16x16x32_bf16 v[124:127], v[120:123], v[64:67], v[124:127]
    ds_read_b128 v[104:107], v1 offset:61440
    ds_read_b128 v[108:111], v1 offset:62464
    v_exp_f32 v61, v61
    v_exp_f32 v62, v62
    v_exp_f32 v63, v63
    v_cvt_pk_bf16_f32 v68, v56, v57
    v_cvt_pk_bf16_f32 v69, v58, v59
    v_cvt_pk_bf16_f32 v70, v60, v61
    v_cvt_pk_bf16_f32 v71, v62, v63
    s_nop 1
    v_mfma_f32_32x32x16_bf16 v[72:87], v[116:119], v[68:71], v[72:87]
    v_mfma_f32_16x16x32_bf16 v[124:127], v[120:123], v[68:71], v[124:127]
    s_waitcnt lgkmcnt(0)
    s_waitcnt vmcnt(2)
    s_barrier
    v_mfma_f32_32x32x16_bf16 v[48:63], v[96:99], v[8:11], v[16:31]
    v_exp_f32 v32, v32
    v_exp_f32 v33, v33
    v_exp_f32 v34, v34
    v_exp_f32 v35, v35
    v_mfma_f32_32x32x16_bf16 v[48:63], v[100:103], v[12:15], v[48:63]
    v_exp_f32 v36, v36
    v_exp_f32 v37, v37
    v_exp_f32 v38, v38
    v_exp_f32 v39, v39
    ds_read_b128 v[88:91], v1 offset:0
    ds_read_b128 v[92:95], v1 offset:1024
    v_cvt_pk_bf16_f32 v64, v32, v33
    v_cvt_pk_bf16_f32 v65, v34, v35
    v_cvt_pk_bf16_f32 v66, v36, v37
    v_cvt_pk_bf16_f32 v67, v38, v39
    v_exp_f32 v40, v40
    v_exp_f32 v41, v41
    v_mfma_f32_32x32x16_bf16 v[72:87], v[104:107], v[64:67], v[72:87]
    v_exp_f32 v42, v42
    v_exp_f32 v43, v43
    v_exp_f32 v44, v44
    v_mfma_f32_16x16x32_bf16 v[124:127], v[120:123], v[64:67], v[124:127]
    ds_read_b128 v[112:115], v1 offset:63488
    ds_read_b128 v[116:119], v1 offset:64512
    v_exp_f32 v45, v45
    v_exp_f32 v46, v46
    v_exp_f32 v47, v47
    s_add_u32 m0, s46, 32768
    s_nop 0
    buffer_load_dwordx4 v1, s[20:23], s40 offen lds
    s_add_u32 m0, s46, 40960
    s_add_u32 s40, s40, 8192
    buffer_load_dwordx4 v1, s[20:23], s41 offen lds
    s_add_u32 s41, s41, 8192
    v_cvt_pk_bf16_f32 v68, v40, v41
    v_cvt_pk_bf16_f32 v69, v42, v43
    v_cvt_pk_bf16_f32 v70, v44, v45
    v_cvt_pk_bf16_f32 v71, v46, v47
    s_nop 1
    v_mfma_f32_32x32x16_bf16 v[72:87], v[108:111], v[68:71], v[72:87]
    v_mfma_f32_16x16x32_bf16 v[124:127], v[120:123], v[68:71], v[124:127]
    s_waitcnt lgkmcnt(0)
    v_mfma_f32_32x32x16_bf16 v[32:47], v[88:91], v[8:11], v[16:31]
    v_exp_f32 v48, v48
    v_exp_f32 v49, v49
    v_exp_f32 v50, v50
    v_exp_f32 v51, v51
    v_mfma_f32_32x32x16_bf16 v[32:47], v[92:95], v[12:15], v[32:47]
    v_exp_f32 v52, v52
    v_exp_f32 v53, v53
    v_exp_f32 v54, v54
    v_exp_f32 v55, v55
    ds_read_b128 v[96:99], v1 offset:2048
    ds_read_b128 v[100:103], v1 offset:3072
    v_cvt_pk_bf16_f32 v64, v48, v49
    v_cvt_pk_bf16_f32 v65, v50, v51
    v_cvt_pk_bf16_f32 v66, v52, v53
    v_cvt_pk_bf16_f32 v67, v54, v55
    v_exp_f32 v56, v56
    v_exp_f32 v57, v57
    v_mfma_f32_32x32x16_bf16 v[72:87], v[112:115], v[64:67], v[72:87]
    v_exp_f32 v58, v58
    v_exp_f32 v59, v59
    v_exp_f32 v60, v60
    v_mfma_f32_16x16x32_bf16 v[124:127], v[120:123], v[64:67], v[124:127]
    ds_read_b128 v[104:107], v1 offset:8192
    ds_read_b128 v[108:111], v1 offset:9216
    v_exp_f32 v61, v61
    v_exp_f32 v62, v62
    v_exp_f32 v63, v63
    v_cvt_pk_bf16_f32 v68, v56, v57
    v_cvt_pk_bf16_f32 v69, v58, v59
    v_cvt_pk_bf16_f32 v70, v60, v61
    v_cvt_pk_bf16_f32 v71, v62, v63
    s_nop 1
    v_mfma_f32_32x32x16_bf16 v[72:87], v[116:119], v[68:71], v[72:87]
    v_mfma_f32_16x16x32_bf16 v[124:127], v[120:123], v[68:71], v[124:127]
    s_waitcnt lgkmcnt(0)
    s_sub_u32 s44, s44, 1
    s_cmp_lg_u32 s44, 0
    s_cbranch_scc1 L_k2_loop
    v_mfma_f32_32x32x16_bf16 v[48:63], v[96:99], v[8:11], v[16:31]
    v_exp_f32 v32, v32
    v_exp_f32 v33, v33
    v_exp_f32 v34, v34
    v_exp_f32 v35, v35
    v_mfma_f32_32x32x16_bf16 v[48:63], v[100:103], v[12:15], v[48:63]
    v_exp_f32 v36, v36
    v_exp_f32 v37, v37
    v_exp_f32 v38, v38
    v_exp_f32 v39, v39
    ds_read_b128 v[88:91], v1 offset:4096
    ds_read_b128 v[92:95], v1 offset:5120
    v_cvt_pk_bf16_f32 v64, v32, v33
    v_cvt_pk_bf16_f32 v65, v34, v35
    v_cvt_pk_bf16_f32 v66, v36, v37
    v_cvt_pk_bf16_f32 v67, v38, v39
    v_exp_f32 v40, v40
    v_exp_f32 v41, v41
    v_mfma_f32_32x32x16_bf16 v[72:87], v[104:107], v[64:67], v[72:87]
    v_exp_f32 v42, v42
    v_exp_f32 v43, v43
    v_exp_f32 v44, v44
    v_mfma_f32_16x16x32_bf16 v[124:127], v[120:123], v[64:67], v[124:127]
    ds_read_b128 v[112:115], v1 offset:10240
    ds_read_b128 v[116:119], v1 offset:11264
    v_exp_f32 v45, v45
    v_exp_f32 v46, v46
    v_exp_f32 v47, v47
    v_cvt_pk_bf16_f32 v68, v40, v41
    v_cvt_pk_bf16_f32 v69, v42, v43
    v_cvt_pk_bf16_f32 v70, v44, v45
    v_cvt_pk_bf16_f32 v71, v46, v47
    s_nop 1
    v_mfma_f32_32x32x16_bf16 v[72:87], v[108:111], v[68:71], v[72:87]
    v_mfma_f32_16x16x32_bf16 v[124:127], v[120:123], v[68:71], v[124:127]
    s_waitcnt lgkmcnt(0)
    v_mfma_f32_32x32x16_bf16 v[32:47], v[88:91], v[8:11], v[16:31]
    v_exp_f32 v48, v48
    v_exp_f32 v49, v49
    v_exp_f32 v50, v50
    v_exp_f32 v51, v51
    v_mfma_f32_32x32x16_bf16 v[32:47], v[92:95], v[12:15], v[32:47]
    v_exp_f32 v52, v52
    v_exp_f32 v53, v53
    v_exp_f32 v54, v54
    v_exp_f32 v55, v55
    ds_read_b128 v[96:99], v1 offset:6144
    ds_read_b128 v[100:103], v1 offset:7168
    v_cvt_pk_bf16_f32 v64, v48, v49
    v_cvt_pk_bf16_f32 v65, v50, v51
    v_cvt_pk_bf16_f32 v66, v52, v53
    v_cvt_pk_bf16_f32 v67, v54, v55
    v_exp_f32 v56, v56
    v_exp_f32 v57, v57
    v_mfma_f32_32x32x16_bf16 v[72:87], v[112:115], v[64:67], v[72:87]
    v_exp_f32 v58, v58
    v_exp_f32 v59, v59
    v_exp_f32 v60, v60
    v_mfma_f32_16x16x32_bf16 v[124:127], v[120:123], v[64:67], v[124:127]
    ds_read_b128 v[104:107], v1 offset:12288
    ds_read_b128 v[108:111], v1 offset:13312
    v_exp_f32 v61, v61
    v_exp_f32 v62, v62
    v_exp_f32 v63, v63
    v_cvt_pk_bf16_f32 v68, v56, v57
    v_cvt_pk_bf16_f32 v69, v58, v59
    v_cvt_pk_bf16_f32 v70, v60, v61
    v_cvt_pk_bf16_f32 v71, v62, v63
    s_nop 1
    v_mfma_f32_32x32x16_bf16 v[72:87], v[116:119], v[68:71], v[72:87]
    v_mfma_f32_16x16x32_bf16 v[124:127], v[120:123], v[68:71], v[124:127]
    s_waitcnt lgkmcnt(0)
    s_waitcnt vmcnt(2)
    s_barrier
    v_mfma_f32_32x32x16_bf16 v[48:63], v[96:99], v[8:11], v[16:31]
    v_exp_f32 v32, v32
    v_exp_f32 v33, v33
    v_exp_f32 v34, v34
    v_exp_f32 v35, v35
    v_mfma_f32_32x32x16_bf16 v[48:63], v[100:103], v[12:15], v[48:63]
    v_exp_f32 v36, v36
    v_exp_f32 v37, v37
    v_exp_f32 v38, v38
    v_exp_f32 v39, v39
    ds_read_b128 v[88:91], v1 offset:16384
    ds_read_b128 v[92:95], v1 offset:17408
    v_cvt_pk_bf16_f32 v64, v32, v33
    v_cvt_pk_bf16_f32 v65, v34, v35
    v_cvt_pk_bf16_f32 v66, v36, v37
    v_cvt_pk_bf16_f32 v67, v38, v39
    v_exp_f32 v40, v40
    v_exp_f32 v41, v41
    v_mfma_f32_32x32x16_bf16 v[72:87], v[104:107], v[64:67], v[72:87]
    v_exp_f32 v42, v42
    v_exp_f32 v43, v43
    v_exp_f32 v44, v44
    v_mfma_f32_16x16x32_bf16 v[124:127], v[120:123], v[64:67], v[124:127]
    ds_read_b128 v[112:115], v1 offset:14336
    ds_read_b128 v[116:119], v1 offset:15360
    v_exp_f32 v45, v45
    v_exp_f32 v46, v46
    v_exp_f32 v47, v47
    s_add_u32 m0, s46, 49152
    s_nop 0
    buffer_load_dwordx4 v1, s[20:23], s40 offen lds
    s_add_u32 m0, s46, 57344
    s_add_u32 s40, s40, 8192
    buffer_load_dwordx4 v1, s[20:23], s41 offen lds
    s_add_u32 s41, s41, 8192
    v_cvt_pk_bf16_f32 v68, v40, v41
    v_cvt_pk_bf16_f32 v69, v42, v43
    v_cvt_pk_bf16_f32 v70, v44, v45
    v_cvt_pk_bf16_f32 v71, v46, v47
    s_nop 1
    v_mfma_f32_32x32x16_bf16 v[72:87], v[108:111], v[68:71], v[72:87]
    v_mfma_f32_16x16x32_bf16 v[124:127], v[120:123], v[68:71], v[124:127]
    s_waitcnt lgkmcnt(0)
    v_mfma_f32_32x32x16_bf16 v[32:47], v[88:91], v[8:11], v[16:31]
    v_exp_f32 v48, v48
    v_exp_f32 v49, v49
    v_exp_f32 v50, v50
    v_exp_f32 v51, v51
    v_mfma_f32_32x32x16_bf16 v[32:47], v[92:95], v[12:15], v[32:47]
    v_exp_f32 v52, v52
    v_exp_f32 v53, v53
    v_exp_f32 v54, v54
    v_exp_f32 v55, v55
    ds_read_b128 v[96:99], v1 offset:18432
    ds_read_b128 v[100:103], v1 offset:19456
    v_cvt_pk_bf16_f32 v64, v48, v49
    v_cvt_pk_bf16_f32 v65, v50, v51
    v_cvt_pk_bf16_f32 v66, v52, v53
    v_cvt_pk_bf16_f32 v67, v54, v55
    v_exp_f32 v56, v56
    v_exp_f32 v57, v57
    v_mfma_f32_32x32x16_bf16 v[72:87], v[112:115], v[64:67], v[72:87]
    v_exp_f32 v58, v58
    v_exp_f32 v59, v59
    v_exp_f32 v60, v60
    v_mfma_f32_16x16x32_bf16 v[124:127], v[120:123], v[64:67], v[124:127]
    ds_read_b128 v[104:107], v1 offset:24576
    ds_read_b128 v[108:111], v1 offset:25600
    v_exp_f32 v61, v61
    v_exp_f32 v62, v62
    v_exp_f32 v63, v63
    v_cvt_pk_bf16_f32 v68, v56, v57
    v_cvt_pk_bf16_f32 v69, v58, v59
    v_cvt_pk_bf16_f32 v70, v60, v61
    v_cvt_pk_bf16_f32 v71, v62, v63
    s_nop 1
    v_mfma_f32_32x32x16_bf16 v[72:87], v[116:119], v[68:71], v[72:87]
    v_mfma_f32_16x16x32_bf16 v[124:127], v[120:123], v[68:71], v[124:127]
    s_waitcnt lgkmcnt(0)
    v_mfma_f32_32x32x16_bf16 v[48:63], v[96:99], v[8:11], v[16:31]
    v_exp_f32 v32, v32
    v_exp_f32 v33, v33
    v_exp_f32 v34, v34
    v_exp_f32 v35, v35
    v_mfma_f32_32x32x16_bf16 v[48:63], v[100:103], v[12:15], v[48:63]
    v_exp_f32 v36, v36
    v_exp_f32 v37, v37
    v_exp_f32 v38, v38
    v_exp_f32 v39, v39
    ds_read_b128 v[88:91], v1 offset:20480
    ds_read_b128 v[92:95], v1 offset:21504
    v_cvt_pk_bf16_f32 v64, v32, v33
    v_cvt_pk_bf16_f32 v65, v34, v35
    v_cvt_pk_bf16_f32 v66, v36, v37
    v_cvt_pk_bf16_f32 v67, v38, v39
    v_exp_f32 v40, v40
    v_exp_f32 v41, v41
    v_mfma_f32_32x32x16_bf16 v[72:87], v[104:107], v[64:67], v[72:87]
    v_exp_f32 v42, v42
    v_exp_f32 v43, v43
    v_exp_f32 v44, v44
    v_mfma_f32_16x16x32_bf16 v[124:127], v[120:123], v[64:67], v[124:127]
    ds_read_b128 v[112:115], v1 offset:26624
    ds_read_b128 v[116:119], v1 offset:27648
    v_exp_f32 v45, v45
    v_exp_f32 v46, v46
    v_exp_f32 v47, v47
    v_cvt_pk_bf16_f32 v68, v40, v41
    v_cvt_pk_bf16_f32 v69, v42, v43
    v_cvt_pk_bf16_f32 v70, v44, v45
    v_cvt_pk_bf16_f32 v71, v46, v47
    s_nop 1
    v_mfma_f32_32x32x16_bf16 v[72:87], v[108:111], v[68:71], v[72:87]
    v_mfma_f32_16x16x32_bf16 v[124:127], v[120:123], v[68:71], v[124:127]
    s_waitcnt lgkmcnt(0)
    v_mfma_f32_32x32x16_bf16 v[32:47], v[88:91], v[8:11], v[16:31]
    v_exp_f32 v48, v48
    v_exp_f32 v49, v49
    v_exp_f32 v50, v50
    v_exp_f32 v51, v51
    v_mfma_f32_32x32x16_bf16 v[32:47], v[92:95], v[12:15], v[32:47]
    v_exp_f32 v52, v52
    v_exp_f32 v53, v53
    v_exp_f32 v54, v54
    v_exp_f32 v55, v55
    ds_read_b128 v[96:99], v1 offset:22528
    ds_read_b128 v[100:103], v1 offset:23552
    v_cvt_pk_bf16_f32 v64, v48, v49
    v_cvt_pk_bf16_f32 v65, v50, v51
    v_cvt_pk_bf16_f32 v66, v52, v53
    v_cvt_pk_bf16_f32 v67, v54, v55
    v_exp_f32 v56, v56
    v_exp_f32 v57, v57
    v_mfma_f32_32x32x16_bf16 v[72:87], v[112:115], v[64:67], v[72:87]
    v_exp_f32 v58, v58
    v_exp_f32 v59, v59
    v_exp_f32 v60, v60
    v_mfma_f32_16x16x32_bf16 v[124:127], v[120:123], v[64:67], v[124:127]
    ds_read_b128 v[104:107], v1 offset:28672
    ds_read_b128 v[108:111], v1 offset:29696
    v_exp_f32 v61, v61
    v_exp_f32 v62, v62
    v_exp_f32 v63, v63
    v_cvt_pk_bf16_f32 v68, v56, v57
    v_cvt_pk_bf16_f32 v69, v58, v59
    v_cvt_pk_bf16_f32 v70, v60, v61
    v_cvt_pk_bf16_f32 v71, v62, v63
    s_nop 1
    v_mfma_f32_32x32x16_bf16 v[72:87], v[116:119], v[68:71], v[72:87]
    v_mfma_f32_16x16x32_bf16 v[124:127], v[120:123], v[68:71], v[124:127]
    s_waitcnt lgkmcnt(0)
    s_waitcnt vmcnt(2)
    s_barrier
    v_mfma_f32_32x32x16_bf16 v[48:63], v[96:99], v[8:11], v[16:31]
    v_exp_f32 v32, v32
    v_exp_f32 v33, v33
    v_exp_f32 v34, v34
    v_exp_f32 v35, v35
    v_mfma_f32_32x32x16_bf16 v[48:63], v[100:103], v[12:15], v[48:63]
    v_exp_f32 v36, v36
    v_exp_f32 v37, v37
    v_exp_f32 v38, v38
    v_exp_f32 v39, v39
    ds_read_b128 v[88:91], v1 offset:32768
    ds_read_b128 v[92:95], v1 offset:33792
    v_cvt_pk_bf16_f32 v64, v32, v33
    v_cvt_pk_bf16_f32 v65, v34, v35
    v_cvt_pk_bf16_f32 v66, v36, v37
    v_cvt_pk_bf16_f32 v67, v38, v39
    v_exp_f32 v40, v40
    v_exp_f32 v41, v41
    v_mfma_f32_32x32x16_bf16 v[72:87], v[104:107], v[64:67], v[72:87]
    v_exp_f32 v42, v42
    v_exp_f32 v43, v43
    v_exp_f32 v44, v44
    v_mfma_f32_16x16x32_bf16 v[124:127], v[120:123], v[64:67], v[124:127]
    ds_read_b128 v[112:115], v1 offset:30720
    ds_read_b128 v[116:119], v1 offset:31744
    v_exp_f32 v45, v45
    v_exp_f32 v46, v46
    v_exp_f32 v47, v47
    v_cvt_pk_bf16_f32 v68, v40, v41
    v_cvt_pk_bf16_f32 v69, v42, v43
    v_cvt_pk_bf16_f32 v70, v44, v45
    v_cvt_pk_bf16_f32 v71, v46, v47
    s_nop 1
    v_mfma_f32_32x32x16_bf16 v[72:87], v[108:111], v[68:71], v[72:87]
    v_mfma_f32_16x16x32_bf16 v[124:127], v[120:123], v[68:71], v[124:127]
    s_waitcnt lgkmcnt(0)
    v_mfma_f32_32x32x16_bf16 v[32:47], v[88:91], v[8:11], v[16:31]
    v_exp_f32 v48, v48
    v_exp_f32 v49, v49
    v_exp_f32 v50, v50
    v_exp_f32 v51, v51
    v_mfma_f32_32x32x16_bf16 v[32:47], v[92:95], v[12:15], v[32:47]
    v_exp_f32 v52, v52
    v_exp_f32 v53, v53
    v_exp_f32 v54, v54
    v_exp_f32 v55, v55
    ds_read_b128 v[96:99], v1 offset:34816
    ds_read_b128 v[100:103], v1 offset:35840
    v_cvt_pk_bf16_f32 v64, v48, v49
    v_cvt_pk_bf16_f32 v65, v50, v51
    v_cvt_pk_bf16_f32 v66, v52, v53
    v_cvt_pk_bf16_f32 v67, v54, v55
    v_exp_f32 v56, v56
    v_exp_f32 v57, v57
    v_mfma_f32_32x32x16_bf16 v[72:87], v[112:115], v[64:67], v[72:87]
    v_exp_f32 v58, v58
    v_exp_f32 v59, v59
    v_exp_f32 v60, v60
    v_mfma_f32_16x16x32_bf16 v[124:127], v[120:123], v[64:67], v[124:127]
    ds_read_b128 v[104:107], v1 offset:40960
    ds_read_b128 v[108:111], v1 offset:41984
    v_exp_f32 v61, v61
    v_exp_f32 v62, v62
    v_exp_f32 v63, v63
    v_cvt_pk_bf16_f32 v68, v56, v57
    v_cvt_pk_bf16_f32 v69, v58, v59
    v_cvt_pk_bf16_f32 v70, v60, v61
    v_cvt_pk_bf16_f32 v71, v62, v63
    s_nop 1
    v_mfma_f32_32x32x16_bf16 v[72:87], v[116:119], v[68:71], v[72:87]
    v_mfma_f32_16x16x32_bf16 v[124:127], v[120:123], v[68:71], v[124:127]
    s_waitcnt lgkmcnt(0)
    v_mfma_f32_32x32x16_bf16 v[48:63], v[96:99], v[8:11], v[16:31]
    v_exp_f32 v32, v32
    v_exp_f32 v33, v33
    v_exp_f32 v34, v34
    v_exp_f32 v35, v35
    v_mfma_f32_32x32x16_bf16 v[48:63], v[100:103], v[12:15], v[48:63]
    v_exp_f32 v36, v36
    v_exp_f32 v37, v37
    v_exp_f32 v38, v38
    v_exp_f32 v39, v39
    ds_read_b128 v[88:91], v1 offset:36864
    ds_read_b128 v[92:95], v1 offset:37888
    v_cvt_pk_bf16_f32 v64, v32, v33
    v_cvt_pk_bf16_f32 v65, v34, v35
    v_cvt_pk_bf16_f32 v66, v36, v37
    v_cvt_pk_bf16_f32 v67, v38, v39
    v_exp_f32 v40, v40
    v_exp_f32 v41, v41
    v_mfma_f32_32x32x16_bf16 v[72:87], v[104:107], v[64:67], v[72:87]
    v_exp_f32 v42, v42
    v_exp_f32 v43, v43
    v_exp_f32 v44, v44
    v_mfma_f32_16x16x32_bf16 v[124:127], v[120:123], v[64:67], v[124:127]
    ds_read_b128 v[112:115], v1 offset:43008
    ds_read_b128 v[116:119], v1 offset:44032
    v_exp_f32 v45, v45
    v_exp_f32 v46, v46
    v_exp_f32 v47, v47
    v_cvt_pk_bf16_f32 v68, v40, v41
    v_cvt_pk_bf16_f32 v69, v42, v43
    v_cvt_pk_bf16_f32 v70, v44, v45
    v_cvt_pk_bf16_f32 v71, v46, v47
    s_nop 1
    v_mfma_f32_32x32x16_bf16 v[72:87], v[108:111], v[68:71], v[72:87]
    v_mfma_f32_16x16x32_bf16 v[124:127], v[120:123], v[68:71], v[124:127]
    s_waitcnt lgkmcnt(0)
    v_mfma_f32_32x32x16_bf16 v[32:47], v[88:91], v[8:11], v[16:31]
    v_exp_f32 v48, v48
    v_exp_f32 v49, v49
    v_exp_f32 v50, v50
    v_exp_f32 v51, v51
    v_mfma_f32_32x32x16_bf16 v[32:47], v[92:95], v[12:15], v[32:47]
    v_exp_f32 v52, v52
    v_exp_f32 v53, v53
    v_exp_f32 v54, v54
    v_exp_f32 v55, v55
    ds_read_b128 v[96:99], v1 offset:38912
    ds_read_b128 v[100:103], v1 offset:39936
    v_cvt_pk_bf16_f32 v64, v48, v49
    v_cvt_pk_bf16_f32 v65, v50, v51
    v_cvt_pk_bf16_f32 v66, v52, v53
    v_cvt_pk_bf16_f32 v67, v54, v55
    v_exp_f32 v56, v56
    v_exp_f32 v57, v57
    v_mfma_f32_32x32x16_bf16 v[72:87], v[112:115], v[64:67], v[72:87]
    v_exp_f32 v58, v58
    v_exp_f32 v59, v59
    v_exp_f32 v60, v60
    v_mfma_f32_16x16x32_bf16 v[124:127], v[120:123], v[64:67], v[124:127]
    ds_read_b128 v[104:107], v1 offset:45056
    ds_read_b128 v[108:111], v1 offset:46080
    v_exp_f32 v61, v61
    v_exp_f32 v62, v62
    v_exp_f32 v63, v63
    v_cvt_pk_bf16_f32 v68, v56, v57
    v_cvt_pk_bf16_f32 v69, v58, v59
    v_cvt_pk_bf16_f32 v70, v60, v61
    v_cvt_pk_bf16_f32 v71, v62, v63
    s_nop 1
    v_mfma_f32_32x32x16_bf16 v[72:87], v[116:119], v[68:71], v[72:87]
    v_mfma_f32_16x16x32_bf16 v[124:127], v[120:123], v[68:71], v[124:127]
    s_waitcnt lgkmcnt(0)
    s_waitcnt vmcnt(0)
    s_barrier
    v_mfma_f32_32x32x16_bf16 v[48:63], v[96:99], v[8:11], v[16:31]
    v_exp_f32 v32, v32
    v_exp_f32 v33, v33
    v_exp_f32 v34, v34
    v_exp_f32 v35, v35
    v_mfma_f32_32x32x16_bf16 v[48:63], v[100:103], v[12:15], v[48:63]
    v_exp_f32 v36, v36
    v_exp_f32 v37, v37
    v_exp_f32 v38, v38
    v_exp_f32 v39, v39
    ds_read_b128 v[88:91], v1 offset:49152
    ds_read_b128 v[92:95], v1 offset:50176
    v_cvt_pk_bf16_f32 v64, v32, v33
    v_cvt_pk_bf16_f32 v65, v34, v35
    v_cvt_pk_bf16_f32 v66, v36, v37
    v_cvt_pk_bf16_f32 v67, v38, v39
    v_exp_f32 v40, v40
    v_exp_f32 v41, v41
    v_mfma_f32_32x32x16_bf16 v[72:87], v[104:107], v[64:67], v[72:87]
    v_exp_f32 v42, v42
    v_exp_f32 v43, v43
    v_exp_f32 v44, v44
    v_mfma_f32_16x16x32_bf16 v[124:127], v[120:123], v[64:67], v[124:127]
    ds_read_b128 v[112:115], v1 offset:47104
    ds_read_b128 v[116:119], v1 offset:48128
    v_exp_f32 v45, v45
    v_exp_f32 v46, v46
    v_exp_f32 v47, v47
    v_cvt_pk_bf16_f32 v68, v40, v41
    v_cvt_pk_bf16_f32 v69, v42, v43
    v_cvt_pk_bf16_f32 v70, v44, v45
    v_cvt_pk_bf16_f32 v71, v46, v47
    s_nop 1
    v_mfma_f32_32x32x16_bf16 v[72:87], v[108:111], v[68:71], v[72:87]
    v_mfma_f32_16x16x32_bf16 v[124:127], v[120:123], v[68:71], v[124:127]
    s_waitcnt lgkmcnt(0)
    v_mfma_f32_32x32x16_bf16 v[32:47], v[88:91], v[8:11], v[16:31]
    v_exp_f32 v48, v48
    v_exp_f32 v49, v49
    v_exp_f32 v50, v50
    v_exp_f32 v51, v51
    v_mfma_f32_32x32x16_bf16 v[32:47], v[92:95], v[12:15], v[32:47]
    v_exp_f32 v52, v52
    v_exp_f32 v53, v53
    v_exp_f32 v54, v54
    v_exp_f32 v55, v55
    ds_read_b128 v[96:99], v1 offset:51200
    ds_read_b128 v[100:103], v1 offset:52224
    v_cvt_pk_bf16_f32 v64, v48, v49
    v_cvt_pk_bf16_f32 v65, v50, v51
    v_cvt_pk_bf16_f32 v66, v52, v53
    v_cvt_pk_bf16_f32 v67, v54, v55
    v_exp_f32 v56, v56
    v_exp_f32 v57, v57
    v_mfma_f32_32x32x16_bf16 v[72:87], v[112:115], v[64:67], v[72:87]
    v_exp_f32 v58, v58
    v_exp_f32 v59, v59
    v_exp_f32 v60, v60
    v_mfma_f32_16x16x32_bf16 v[124:127], v[120:123], v[64:67], v[124:127]
    ds_read_b128 v[104:107], v1 offset:57344
    ds_read_b128 v[108:111], v1 offset:58368
    v_exp_f32 v61, v61
    v_exp_f32 v62, v62
    v_exp_f32 v63, v63
    v_cvt_pk_bf16_f32 v68, v56, v57
    v_cvt_pk_bf16_f32 v69, v58, v59
    v_cvt_pk_bf16_f32 v70, v60, v61
    v_cvt_pk_bf16_f32 v71, v62, v63
    s_nop 1
    v_mfma_f32_32x32x16_bf16 v[72:87], v[116:119], v[68:71], v[72:87]
    v_mfma_f32_16x16x32_bf16 v[124:127], v[120:123], v[68:71], v[124:127]
    s_waitcnt lgkmcnt(0)
    v_mfma_f32_32x32x16_bf16 v[48:63], v[96:99], v[8:11], v[16:31]
    v_exp_f32 v32, v32
    v_exp_f32 v33, v33
    v_exp_f32 v34, v34
    v_exp_f32 v35, v35
    v_mfma_f32_32x32x16_bf16 v[48:63], v[100:103], v[12:15], v[48:63]
    v_exp_f32 v36, v36
    v_exp_f32 v37, v37
    v_exp_f32 v38, v38
    v_exp_f32 v39, v39
    ds_read_b128 v[88:91], v1 offset:53248
    ds_read_b128 v[92:95], v1 offset:54272
    v_cvt_pk_bf16_f32 v64, v32, v33
    v_cvt_pk_bf16_f32 v65, v34, v35
    v_cvt_pk_bf16_f32 v66, v36, v37
    v_cvt_pk_bf16_f32 v67, v38, v39
    v_exp_f32 v40, v40
    v_exp_f32 v41, v41
    v_mfma_f32_32x32x16_bf16 v[72:87], v[104:107], v[64:67], v[72:87]
    v_exp_f32 v42, v42
    v_exp_f32 v43, v43
    v_exp_f32 v44, v44
    v_mfma_f32_16x16x32_bf16 v[124:127], v[120:123], v[64:67], v[124:127]
    ds_read_b128 v[112:115], v1 offset:59392
    ds_read_b128 v[116:119], v1 offset:60416
    v_exp_f32 v45, v45
    v_exp_f32 v46, v46
    v_exp_f32 v47, v47
    v_cvt_pk_bf16_f32 v68, v40, v41
    v_cvt_pk_bf16_f32 v69, v42, v43
    v_cvt_pk_bf16_f32 v70, v44, v45
    v_cvt_pk_bf16_f32 v71, v46, v47
    s_nop 1
    v_mfma_f32_32x32x16_bf16 v[72:87], v[108:111], v[68:71], v[72:87]
    v_mfma_f32_16x16x32_bf16 v[124:127], v[120:123], v[68:71], v[124:127]
    s_waitcnt lgkmcnt(0)
    v_mfma_f32_32x32x16_bf16 v[32:47], v[88:91], v[8:11], v[16:31]
    v_exp_f32 v48, v48
    v_exp_f32 v49, v49
    v_exp_f32 v50, v50
    v_exp_f32 v51, v51
    v_mfma_f32_32x32x16_bf16 v[32:47], v[92:95], v[12:15], v[32:47]
    v_exp_f32 v52, v52
    v_exp_f32 v53, v53
    v_exp_f32 v54, v54
    v_exp_f32 v55, v55
    ds_read_b128 v[96:99], v1 offset:55296
    ds_read_b128 v[100:103], v1 offset:56320
    v_cvt_pk_bf16_f32 v64, v48, v49
    v_cvt_pk_bf16_f32 v65, v50, v51
    v_cvt_pk_bf16_f32 v66, v52, v53
    v_cvt_pk_bf16_f32 v67, v54, v55
    v_exp_f32 v56, v56
    v_exp_f32 v57, v57
    v_mfma_f32_32x32x16_bf16 v[72:87], v[112:115], v[64:67], v[72:87]
    v_exp_f32 v58, v58
    v_exp_f32 v59, v59
    v_exp_f32 v60, v60
    v_mfma_f32_16x16x32_bf16 v[124:127], v[120:123], v[64:67], v[124:127]
    ds_read_b128 v[104:107], v1 offset:61440
    ds_read_b128 v[108:111], v1 offset:62464
    v_exp_f32 v61, v61
    v_exp_f32 v62, v62
    v_exp_f32 v63, v63
    v_cvt_pk_bf16_f32 v68, v56, v57
    v_cvt_pk_bf16_f32 v69, v58, v59
    v_cvt_pk_bf16_f32 v70, v60, v61
    v_cvt_pk_bf16_f32 v71, v62, v63
    s_nop 1
    v_mfma_f32_32x32x16_bf16 v[72:87], v[116:119], v[68:71], v[72:87]
    v_mfma_f32_16x16x32_bf16 v[124:127], v[120:123], v[68:71], v[124:127]
    s_waitcnt lgkmcnt(0)
    v_mfma_f32_32x32x16_bf16 v[48:63], v[96:99], v[8:11], v[16:31]
    v_exp_f32 v32, v32
    v_exp_f32 v33, v33
    v_exp_f32 v34, v34
    v_exp_f32 v35, v35
    v_mfma_f32_32x32x16_bf16 v[48:63], v[100:103], v[12:15], v[48:63]
    v_exp_f32 v36, v36
    v_exp_f32 v37, v37
    v_exp_f32 v38, v38
    v_exp_f32 v39, v39
    ds_read_b128 v[112:115], v1 offset:63488
    ds_read_b128 v[116:119], v1 offset:64512
    v_cvt_pk_bf16_f32 v64, v32, v33
    v_cvt_pk_bf16_f32 v65, v34, v35
    v_cvt_pk_bf16_f32 v66, v36, v37
    v_cvt_pk_bf16_f32 v67, v38, v39
    v_exp_f32 v40, v40
    v_exp_f32 v41, v41
    v_mfma_f32_32x32x16_bf16 v[72:87], v[104:107], v[64:67], v[72:87]
    v_exp_f32 v42, v42
    v_exp_f32 v43, v43
    v_exp_f32 v44, v44
    v_mfma_f32_16x16x32_bf16 v[124:127], v[120:123], v[64:67], v[124:127]
    v_exp_f32 v45, v45
    v_exp_f32 v46, v46
    v_exp_f32 v47, v47
    v_cvt_pk_bf16_f32 v68, v40, v41
    v_cvt_pk_bf16_f32 v69, v42, v43
    v_cvt_pk_bf16_f32 v70, v44, v45
    v_cvt_pk_bf16_f32 v71, v46, v47
    s_nop 1
    v_mfma_f32_32x32x16_bf16 v[72:87], v[108:111], v[68:71], v[72:87]
    v_mfma_f32_16x16x32_bf16 v[124:127], v[120:123], v[68:71], v[124:127]
    s_waitcnt lgkmcnt(0)
    v_exp_f32 v48, v48
    v_exp_f32 v49, v49
    v_exp_f32 v50, v50
    v_exp_f32 v51, v51
    v_exp_f32 v52, v52
    v_exp_f32 v53, v53
    v_exp_f32 v54, v54
    v_exp_f32 v55, v55
    v_cvt_pk_bf16_f32 v64, v48, v49
    v_cvt_pk_bf16_f32 v65, v50, v51
    v_cvt_pk_bf16_f32 v66, v52, v53
    v_cvt_pk_bf16_f32 v67, v54, v55
    v_exp_f32 v56, v56
    v_exp_f32 v57, v57
    v_mfma_f32_32x32x16_bf16 v[72:87], v[112:115], v[64:67], v[72:87]
    v_exp_f32 v58, v58
    v_exp_f32 v59, v59
    v_exp_f32 v60, v60
    v_mfma_f32_16x16x32_bf16 v[124:127], v[120:123], v[64:67], v[124:127]
    v_exp_f32 v61, v61
    v_exp_f32 v62, v62
    v_exp_f32 v63, v63
    v_cvt_pk_bf16_f32 v68, v56, v57
    v_cvt_pk_bf16_f32 v69, v58, v59
    v_cvt_pk_bf16_f32 v70, v60, v61
    v_cvt_pk_bf16_f32 v71, v62, v63
    s_nop 1
    v_mfma_f32_32x32x16_bf16 v[72:87], v[116:119], v[68:71], v[72:87]
    v_mfma_f32_16x16x32_bf16 v[124:127], v[120:123], v[68:71], v[124:127]
    s_waitcnt lgkmcnt(0)
    s_nop 15
    v_mov_b32 v4, v124
    v_mov_b32 v5, v125
    s_nop 1
    v_permlane16_swap_b32 v4, v5
    v_mov_b32 v5, v4
    s_nop 1
    v_permlane32_swap_b32 v4, v5
L_k2_fin:
    v_mul_f32 v6, 0, v4
    v_rcp_f32 v4, v4
    s_nop 0
    v_mul_f32 v72, v72, v4
    v_mul_f32 v73, v73, v4
    v_mul_f32 v74, v74, v4
    v_mul_f32 v75, v75, v4
    v_mul_f32 v76, v76, v4
    v_mul_f32 v77, v77, v4
    v_mul_f32 v78, v78, v4
    v_mul_f32 v79, v79, v4
    v_mul_f32 v80, v80, v4
    v_mul_f32 v81, v81, v4
    v_mul_f32 v82, v82, v4
    v_mul_f32 v83, v83, v4
    v_mul_f32 v84, v84, v4
    v_mul_f32 v85, v85, v4
    v_mul_f32 v86, v86, v4
    v_mul_f32 v87, v87, v4
    v_fmac_f32 v6, 0, v72
    v_fmac_f32 v6, 0, v73
    v_fmac_f32 v6, 0, v74
    v_fmac_f32 v6, 0, v75
    v_fmac_f32 v6, 0, v76
    v_fmac_f32 v6, 0, v77
    v_fmac_f32 v6, 0, v78
    v_fmac_f32 v6, 0, v79
    v_fmac_f32 v6, 0, v80
    v_fmac_f32 v6, 0, v81
    v_fmac_f32 v6, 0, v82
    v_fmac_f32 v6, 0, v83
    v_fmac_f32 v6, 0, v84
    v_fmac_f32 v6, 0, v85
    v_fmac_f32 v6, 0, v86
    v_fmac_f32 v6, 0, v87
    v_cmp_u_f32 vcc, v6, v6
    s_cbranch_vccnz L_k2_slow
L_k2_store:
    v_cvt_pk_bf16_f32 v64, v72, v73
    v_cvt_pk_bf16_f32 v65, v74, v75
    v_cvt_pk_bf16_f32 v66, v76, v77
    v_cvt_pk_bf16_f32 v67, v78, v79
    v_cvt_pk_bf16_f32 v68, v80, v81
    v_cvt_pk_bf16_f32 v69, v82, v83
    v_cvt_pk_bf16_f32 v70, v84, v85
    v_cvt_pk_bf16_f32 v71, v86, v87
    v_and_b32 v4, 15, v0
    v_lshlrev_b32 v4, 4, v4
    v_bfe_u32 v5, v0, 4, 1
    s_mov_b32 s45, 147456
    v_mul_lo_u32 v5, v5, s45
    v_add_u32 v4, v4, v5
    v_lshrrev_b32 v5, 5, v0
    v_lshl_add_u32 v4, v5, 8, v4
    s_mul_i32 s45, s38, 294912
    s_lshl_b32 s46, s37, 10
    s_add_u32 s45, s45, s46
    s_add_u32 s45, s45, 12697600
    v_permlane32_swap_b32 v64, v66
    v_permlane32_swap_b32 v65, v67
    v_permlane32_swap_b32 v68, v70
    v_permlane32_swap_b32 v69, v71
    buffer_store_dwordx4 v[64:67], v4, s[20:23], s45 offen offset:0 sc1
    buffer_store_dwordx4 v[68:71], v4, s[20:23], s45 offen offset:512 sc1
    s_waitcnt vmcnt(0)
    s_barrier
    s_cmp_lg_u32 s34, 0
    s_cbranch_scc1 L_k2_nosig
    s_lshr_b32 s45, s38, 3
    s_lshl_b32 s45, s45, 8
    s_add_u32 s45, s45, 33619968
    v_mov_b32 v4, 0
    v_mov_b32 v5, 1
    s_mov_b64 exec, 1
    buffer_atomic_add v5, v4, s[20:23], s45 offen sc1
    s_mov_b64 exec, -1
L_k2_nosig:
    s_endpgm
L_k2_slow:
    s_cmp_eq_u32 s60, 0x1234567
    s_cbranch_scc1 L_k2_store
    s_mov_b32 s60, 0x1234567
    s_add_u32 s40, s39, 4194304
    s_add_u32 s41, s39, 8388608
    v_mov_b32 v72, 0
    v_mov_b32 v73, 0
    v_mov_b32 v74, 0
    v_mov_b32 v75, 0
    v_mov_b32 v76, 0
    v_mov_b32 v77, 0
    v_mov_b32 v78, 0
    v_mov_b32 v79, 0
    v_mov_b32 v80, 0
    v_mov_b32 v81, 0
    v_mov_b32 v82, 0
    v_mov_b32 v83, 0
    v_mov_b32 v84, 0
    v_mov_b32 v85, 0
    v_mov_b32 v86, 0
    v_mov_b32 v87, 0
    v_mov_b32 v3, 0
    v_mov_b32 v2, 0xff7fffff
    s_mov_b32 s44, 64
L_k2_slowloop:
    buffer_load_dwordx4 v[88:91], v1, s[20:23], s40 offen
    buffer_load_dwordx4 v[92:95], v1, s[20:23], s40 offen offset:1024
    buffer_load_dwordx4 v[104:107], v1, s[20:23], s41 offen
    buffer_load_dwordx4 v[108:111], v1, s[20:23], s41 offen offset:1024
    s_add_u32 s40, s40, 2048
    s_add_u32 s41, s41, 2048
    s_waitcnt vmcnt(0)
    v_mfma_f32_32x32x16_bf16 v[32:47], v[88:91], v[8:11], 0
    v_mfma_f32_32x32x16_bf16 v[32:47], v[92:95], v[12:15], v[32:47]
    s_nop 15
    v_max3_f32 v4, v32, v33, v34
    v_max3_f32 v5, v35, v36, v37
    v_max3_f32 v4, v4, v38, v39
    v_max3_f32 v5, v5, v40, v41
    v_max3_f32 v4, v4, v42, v43
    v_max3_f32 v5, v5, v44, v45
    v_max3_f32 v4, v4, v46, v47
    v_max_f32 v4, v4, v5
    v_mov_b32 v5, v4
    s_nop 1
    v_permlane32_swap_b32 v4, v5
    v_max_f32 v4, v4, v5
    v_max_f32 v4, v4, v2
    v_sub_f32 v5, v2, v4
    v_exp_f32 v5, v5
    v_mov_b32 v2, v4
    v_sub_f32 v32, v32, v4
    v_sub_f32 v33, v33, v4
    v_sub_f32 v34, v34, v4
    v_sub_f32 v35, v35, v4
    v_sub_f32 v36, v36, v4
    v_sub_f32 v37, v37, v4
    v_sub_f32 v38, v38, v4
    v_sub_f32 v39, v39, v4
    v_sub_f32 v40, v40, v4
    v_sub_f32 v41, v41, v4
    v_sub_f32 v42, v42, v4
    v_sub_f32 v43, v43, v4
    v_sub_f32 v44, v44, v4
    v_sub_f32 v45, v45, v4
    v_sub_f32 v46, v46, v4
    v_sub_f32 v47, v47, v4
    v_exp_f32 v32, v32
    v_exp_f32 v33, v33
    v_exp_f32 v34, v34
    v_exp_f32 v35, v35
    v_exp_f32 v36, v36
    v_exp_f32 v37, v37
    v_exp_f32 v38, v38
    v_exp_f32 v39, v39
    v_exp_f32 v40, v40
    v_exp_f32 v41, v41
    v_exp_f32 v42, v42
    v_exp_f32 v43, v43
    v_exp_f32 v44, v44
    v_exp_f32 v45, v45
    v_exp_f32 v46, v46
    v_exp_f32 v47, v47
    v_mul_f32 v72, v72, v5
    v_mul_f32 v73, v73, v5
    v_mul_f32 v74, v74, v5
    v_mul_f32 v75, v75, v5
    v_mul_f32 v76, v76, v5
    v_mul_f32 v77, v77, v5
    v_mul_f32 v78, v78, v5
    v_mul_f32 v79, v79, v5
    v_mul_f32 v80, v80, v5
    v_mul_f32 v81, v81, v5
    v_mul_f32 v82, v82, v5
    v_mul_f32 v83, v83, v5
    v_mul_f32 v84, v84, v5
    v_mul_f32 v85, v85, v5
    v_mul_f32 v86, v86, v5
    v_mul_f32 v87, v87, v5
    v_mul_f32 v3, v3, v5
    v_cvt_pk_bf16_f32 v64, v32, v33
    v_cvt_pk_bf16_f32 v65, v34, v35
    v_cvt_pk_bf16_f32 v66, v36, v37
    v_cvt_pk_bf16_f32 v67, v38, v39
    v_cvt_pk_bf16_f32 v68, v40, v41
    v_cvt_pk_bf16_f32 v69, v42, v43
    v_cvt_pk_bf16_f32 v70, v44, v45
    v_cvt_pk_bf16_f32 v71, v46, v47
    v_add_f32 v3, v3, v32
    v_add_f32 v3, v3, v33
    v_add_f32 v3, v3, v34
    v_add_f32 v3, v3, v35
    v_add_f32 v3, v3, v36
    v_add_f32 v3, v3, v37
    v_add_f32 v3, v3, v38
    v_add_f32 v3, v3, v39
    v_add_f32 v3, v3, v40
    v_add_f32 v3, v3, v41
    v_add_f32 v3, v3, v42
    v_add_f32 v3, v3, v43
    v_add_f32 v3, v3, v44
    v_add_f32 v3, v3, v45
    v_add_f32 v3, v3, v46
    v_add_f32 v3, v3, v47
    v_mfma_f32_32x32x16_bf16 v[72:87], v[104:107], v[64:67], v[72:87]
    v_mfma_f32_32x32x16_bf16 v[72:87], v[108:111], v[68:71], v[72:87]
    s_nop 15
    s_sub_u32 s44, s44, 1
    s_cmp_lg_u32 s44, 0
    s_cbranch_scc1 L_k2_slowloop
    v_mov_b32 v4, v3
    v_mov_b32 v5, v3
    s_nop 1
    v_permlane32_swap_b32 v4, v5
    v_add_f32 v4, v4, v5
    s_branch L_k2_fin
L_k2_end:
    s_endpgm
.section .rodata,"a"
.p2align 6
.p2align 6
.amdhsa_kernel k1_kernel
  .amdhsa_next_free_vgpr 256
  .amdhsa_next_free_sgpr 102
  .amdhsa_accum_offset 256
  .amdhsa_group_segment_fixed_size 0
  .amdhsa_kernarg_size 88
  .amdhsa_user_sgpr_count 2
  .amdhsa_user_sgpr_kernarg_segment_ptr 1
  .amdhsa_system_sgpr_workgroup_id_x 1
.end_amdhsa_kernel
.p2align 6
.amdhsa_kernel k2_kernel
  .amdhsa_next_free_vgpr 128
  .amdhsa_next_free_sgpr 102
  .amdhsa_accum_offset 128
  .amdhsa_group_segment_fixed_size 0
  .amdhsa_kernarg_size 88
  .amdhsa_user_sgpr_count 2
  .amdhsa_user_sgpr_kernarg_segment_ptr 1
  .amdhsa_system_sgpr_workgroup_id_x 1
.end_amdhsa_kernel
```
